```python
import torch

def _softmax(x, axis=-1):
    return torch.softmax(x, dim=axis)
def _gelu(x):
    return torch.nn.functional.gelu(x, approximate="tanh")
def _silu(x):
    return torch.nn.functional.silu(x)
def _sigmoid(x):
    return torch.sigmoid(x)
def _layernorm(x, axis=-1, eps=1e-5):
    m = x.mean(dim=axis, keepdim=True)
    v = x.var(dim=axis, keepdim=True, unbiased=False)
    return (x - m) / torch.sqrt(v + eps)
def _scatter_add(tgt, idx, src, axis=0):
    return tgt.clone().index_add_(axis, idx, src)
def _segment_sum(src, seg, n):
    out = torch.zeros((n,) + src.shape[1:], dtype=src.dtype)
    return out.index_add_(0, seg, src)
def _pad(x, pw):
    flat = tuple(v for pair in reversed(pw) for v in pair)
    return torch.nn.functional.pad(x, flat)

kernel_name = 'sequential_preLN__ssm_conv_s4d__moe_arch_mod__prompt'

def setup_inputs():

    _w = (lambda a: (lambda t: t.to(torch.bfloat16) if t.is_floating_point() else t)(torch.as_tensor(a)))
    def _A_setup():
        Bsz, L, D, N = 1, 2048, 512, 128
        return {
            "u": _w((lambda *s: torch.randn(*s, dtype=torch.bfloat16) * 0.1)(Bsz, L, D)),
            "log_A_real": _w((lambda *s: torch.randn(*s, dtype=torch.bfloat16) * 6.4)(D, N) * 0.5),
            "A_imag": _w((lambda *s: torch.randn(*s, dtype=torch.bfloat16) * 0.1)(D, N) * 3.14),
            "C_real": _w((lambda *s: torch.randn(*s, dtype=torch.bfloat16) * 0.1)(D, N) / N ** 0.5),
            "C_imag": _w((lambda *s: torch.randn(*s, dtype=torch.bfloat16) * 0.1)(D, N) / N ** 0.5),
            "log_dt": _w((lambda *s: torch.randn(*s, dtype=torch.bfloat16) * 0.1)(D) * 0.5 - 4.0),
            "D_skip": _w((lambda *s: torch.randn(*s, dtype=torch.bfloat16) * 0.1)(D)),
        }
    _A_in = _A_setup()

    def _B_setup():
        B, S, D, F, C = 1, 2048, 512, 1792, 8
        return {
            "x": _w((lambda *s: torch.randn(*s, dtype=torch.bfloat16) * 0.1)(B, S, D)),
            "w_r": _w((lambda *s: torch.randn(*s, dtype=torch.bfloat16) * 0.1)(D)),
            "w_gate": _w((lambda *s: torch.randn(*s, dtype=torch.bfloat16) * 0.1)(D, F)),
            "w_up": _w((lambda *s: torch.randn(*s, dtype=torch.bfloat16) * 0.1)(D, F)),
            "w_down": _w((lambda *s: torch.randn(*s, dtype=torch.bfloat16) * 0.1)(F, D)),
        }
    _B_in = _B_setup()

    return {
        "A_u": _A_in["u"],
        "A_log_A_real": _A_in["log_A_real"],
        "A_A_imag": _A_in["A_imag"],
        "A_C_real": _A_in["C_real"],
        "A_C_imag": _A_in["C_imag"],
        "A_log_dt": _A_in["log_dt"],
        "A_D_skip": _A_in["D_skip"],
        "B_x": _B_in["x"],
        "B_w_r": _B_in["w_r"],
        "B_w_gate": _B_in["w_gate"],
        "B_w_up": _B_in["w_up"],
        "B_w_down": _B_in["w_down"],
    }

def reference(A_u, A_log_A_real, A_A_imag, A_C_real, A_C_imag, A_log_dt, A_D_skip, B_x, B_w_r, B_w_gate, B_w_up, B_w_down):
    def _A_ref(u, log_A_real, A_imag, C_real, C_imag, log_dt, D_skip):
        L = u.shape[1]
        dt = torch.exp(log_dt)
        A = -torch.exp(log_A_real) + 1j * A_imag
        C = (C_real + 1j * C_imag) * dt[:, None]
        pos = (lambda x, dt: x.to(dt))(torch.arange(L), log_dt.dtype)
        P = torch.exp((A * dt[:, None])[:, :, None] * pos[None, None, :])
        K = 2.0 * torch.einsum("dn,dnl->dl", C, P).real
        L2 = 2 * L
        u_t = (lambda x, *d: x.permute(*d))(u, 0, 2, 1)
        Kf = (lambda x, *a, **k: torch.fft.rfft(x.float(), *a, **k))(K, L2)
        Uf = (lambda x, *a, **k: torch.fft.rfft(x.float(), *a, **k))(u_t, L2)
        y = (lambda x, *a, **k: torch.fft.irfft(x, *a, **k).to(torch.bfloat16))(Uf * Kf[None, :, :], L2)[:, :, :L]
        y = (lambda x, *d: x.permute(*d))(y, 0, 2, 1)
        return y + u * D_skip[None, None, :]

    def _B_ref(x, w_r, w_gate, w_up, w_down):
        B, S, D = x.shape
        C = 8
        r = x @ w_r
        idx = torch.argsort(-r, axis=-1)[:, :C]
        idx_e = (lambda x, n, axis: torch.repeat_interleave(x, n, dim=axis))(idx.reshape(B, C, 1), D, axis=2)
        x_sel = (lambda x, i, axis: torch.take_along_dim(x, i, dim=axis))(x, idx_e, axis=1)
        g = _silu(x_sel @ w_gate)
        u = x_sel @ w_up
        y = (g * u) @ w_down
        r_sel = _sigmoid((lambda x, i, axis: torch.take_along_dim(x, i, dim=axis))(r, idx, axis=1))
        y = y * r_sel.reshape(B, C, 1)
        b_off = (torch.arange(B) * S).reshape(B, 1)
        flat_idx = (idx + b_off).reshape(B * C)
        zero = (x * 0.0).reshape(B * S, D)
        upd = _scatter_add(zero, flat_idx, y.reshape(B * C, D), axis=0)
        return x + upd.reshape(B, S, D)

    x = A_u
    h = x + _A_ref(_layernorm(x, axis=-1), A_log_A_real, A_A_imag, A_C_real, A_C_imag, A_log_dt, A_D_skip)
    h2 = h + _B_ref(_layernorm(h, axis=-1), B_w_r, B_w_gate, B_w_up, B_w_down)
    return h2
```

```asm
; @launch grid=(256,1,1) block=(576,1,1) lds=163840
.amdgcn_target "amdgcn-amd-amdhsa--gfx950"
.text
.globl sequential_preLN__ssm_conv_s4d__moe_arch_mod__prompt_kernel
.p2align 8
.type sequential_preLN__ssm_conv_s4d__moe_arch_mod__prompt_kernel,@function
sequential_preLN__ssm_conv_s4d__moe_arch_mod__prompt_kernel:
    s_cmp_ge_u32 s2, 256
    s_cbranch_scc1 L_END
    s_load_dwordx16 s[8:23], s[0:1], 0
    s_load_dwordx8 s[24:31], s[0:1], 64
    s_load_dwordx4 s[32:35], s[0:1], 96
    s_load_dwordx2 s[36:37], s[0:1], 112
    s_getpc_b64 s[46:47]
L_PC:
    s_lshr_b32 s48, s2, 3
    s_mul_i32 s48, s48, 768
    v_lshlrev_b32 v46, 7, v0
    v_add_u32 v46, s48, v46
    v_min_u32 v46, L_CODE_END-L_PC-4, v46
    v_cmp_gt_u32 vcc, 6, v0
    s_nop 0
    s_and_saveexec_b64 s[50:51], vcc
    s_cbranch_execz L_NOPF
    global_load_dword v79, v46, s[46:47]
L_NOPF:
    s_mov_b64 exec, s[50:51]
    v_lshrrev_b32 v46, 6, v0
    v_and_b32 v1, 63, v0
    v_lshlrev_b32 v3, 4, v0
    v_readfirstlane_b32 s39, v46
    s_and_b32 s48, s2, 7
    s_lshl_b32 s48, s48, 5
    s_lshr_b32 s49, s2, 3
    s_add_u32 s38, s48, s49
    v_lshlrev_b32 v16, 4, v1
    s_cmp_eq_u32 s39, 8
    s_cbranch_scc1 L_SERVICE
    s_lshl_b32 s69, s38, 3
    s_add_u32 s69, s69, s39
    s_lshl_b32 s48, s69, 10
    v_add_u32 v46, s48, v16
    s_bfe_u32 s52, s39, 0x10001
    s_lshl_b32 s48, s38, 1
    s_add_u32 s48, s48, s52
    s_lshl_b32 s48, s48, 8
    s_and_b32 s49, s39, 1
    s_lshl_b32 s49, s49, 7
    s_add_u32 s48, s48, s49
    v_lshlrev_b32 v47, 1, v1
    v_add_u32 v47, s48, v47
    v_xor_b32 v48, 0x80, v47
    v_mov_b32 v40, 0
    v_mov_b32 v41, 0
    v_mov_b32 v42, 0
    v_mov_b32 v43, 0
    v_mov_b32 v44, 0
    v_mov_b32 v45, 0
    s_lshl_b32 s53, s38, 2
    s_waitcnt lgkmcnt(0)
    global_load_dwordx4 v[4:7], v46, s[8:9]
    global_load_short_d16_hi v40, v47, s[10:11]
    global_load_short_d16_hi v41, v47, s[12:13]
    s_cmp_ge_u32 s39, 4
    s_cbranch_scc0 L_nog1
    global_load_short_d16_hi v42, v47, s[14:15]
    global_load_short_d16_hi v43, v47, s[16:17]
    global_load_short_d16_hi v44, v48, s[14:15]
    global_load_short_d16_hi v45, v48, s[16:17]
L_nog1:
    s_load_dword s45, s[18:19], s53
    s_load_dword s44, s[36:37], 0
    s_add_u32 s56, s36, 0x10000
    s_addc_u32 s57, s37, 0
    s_add_u32 s58, s36, 0x218000
    s_addc_u32 s59, s37, 0
    s_add_u32 s60, s36, 0x420000
    s_addc_u32 s61, s37, 0
    s_add_u32 s62, s36, 0x422000
    s_addc_u32 s63, s37, 0
    s_add_u32 s64, s36, 0x430000
    s_addc_u32 s65, s37, 0
    s_add_u32 s66, s36, 0x630000
    s_addc_u32 s67, s37, 0
    s_and_b32 s48, s2, 7
    s_mul_i32 s49, s48, 14
    s_lshr_b32 s50, s2, 3
    s_add_u32 s49, s49, s50
    s_lshl_b32 s48, s48, 3
    s_sub_u32 s50, s50, 14
    s_add_u32 s48, s48, s50
    s_cmp_lt_u32 s2, 112
    s_cselect_b32 s68, s49, s48
    s_mul_i32 s48, s52, 29568
    s_and_b32 s49, s39, 1
    s_lshl_b32 s49, s49, 8
    s_add_u32 s48, s48, s49
    v_lshlrev_b32 v18, 2, v1
    v_add_u32 v18, s48, v18
    s_mul_i32 s48, s38, 8320
    v_add_u32 v17, s48, v3
    s_mul_i32 s48, s39, 1088
    s_add_u32 s48, s48, 108032
    v_add_u32 v36, s48, v16
    v_bfe_u32 v37, v0, 2, 2
    v_mul_u32_u24 v37, 1088, v37
    v_lshrrev_b32 v49, 4, v0
    v_lshlrev_b32 v49, 5, v49
    v_and_b32 v50, 3, v0
    v_lshlrev_b32 v50, 3, v50
    v_add3_u32 v37, v37, v49, v50
    v_add_u32 v37, 108032, v37
    s_lshr_b32 s48, s39, 2
    s_mul_i32 s48, s48, 29568
    s_bfe_u32 s53, s39, 0x10001
    s_and_b32 s54, s39, 1
    v_and_b32 v46, 15, v1
    v_lshrrev_b32 v47, 4, v1
    v_and_b32 v48, 1, v47
    v_lshlrev_b32 v48, 8, v48
    v_lshrrev_b32 v49, 1, v47
    v_lshlrev_b32 v49, 7, v49
    v_add_u32 v48, v48, v49
    s_mul_i32 s49, s54, 8448
    s_add_u32 s49, s49, s48
    s_add_u32 s49, s49, 12672
    v_mul_u32_u24 v19, 528, v46
    v_add3_u32 v19, v19, v48, s49
    s_mov_b32 s50, 0x1234567
    s_mov_b32 s51, 0x889aaabc
    s_mov_b32 s55, 0
    s_cmp_eq_u32 s53, 0
    s_cselect_b32 s50, s50, 0x33450012
    s_cselect_b32 s51, s51, 0x6666a987
    s_cselect_b32 s55, 0, 13
    v_lshlrev_b32 v49, 2, v46
    v_lshrrev_b64 v[50:51], v49, s[50:51]
    v_and_b32 v50, 15, v50
    v_add_u32 v50, s55, v50
    v_mul_u32_u24 v20, 528, v50
    v_add3_u32 v20, v20, v48, s48
    s_lshr_b32 s48, s39, 2
    s_mul_i32 s48, s48, 12544
    s_add_u32 s48, s48, 68544
    s_cmp_eq_u32 s53, 0
    s_cbranch_scc0 L_er12
    s_lshl_b32 s55, s54, 8
    s_sub_u32 s49, s48, s55
    s_add_u32 s49, s49, 2176
    v_lshrrev_b32 v49, 1, v47
    v_lshlrev_b32 v49, 9, v49
    v_lshlrev_b32 v50, 4, v46
    v_add_u32 v49, v49, v50
    v_and_b32 v50, 1, v47
    v_lshlrev_b32 v50, 3, v50
    v_sub_u32 v50, v50, v49
    v_add_u32 v22, s49, v50
    s_branch L_erj3
L_er12:
    s_lshl_b32 s55, s54, 8
    s_sub_u32 s49, s48, s55
    s_add_u32 s49, s49, 1152
    v_lshlrev_b32 v49, 9, v47
    v_lshlrev_b32 v50, 4, v46
    v_add_u32 v49, v49, v50
    v_sub_u32 v22, s49, v49
    v_and_b32 v49, 3, v46
    v_mul_u32_u24 v49, 192, v49
    v_lshrrev_b32 v50, 2, v46
    v_lshlrev_b32 v50, 1, v50
    v_sub_u32 v49, v49, v50
    s_lshl_b32 s55, s54, 3
    s_sub_u32 s49, s48, s55
    s_add_u32 s49, s49, 2390
    v_add_u32 v23, s49, v49
    v_mov_b32 v31, s48
L_erj3:
    v_mov_b32 v32, 0
    v_mov_b32 v33, 0
    v_mov_b32 v34, 0
    v_mov_b32 v35, 0
    v_lshrrev_b32 v46, 1, v0
    s_movk_i32 s48, 8320
    v_mul_lo_u32 v2, v46, s48
    v_and_b32 v47, 1, v0
    v_lshlrev_b32 v48, 4, v47
    s_lshl_b32 s48, s38, 5
    v_add3_u32 v2, v2, v48, s48
    v_cmp_le_u32 vcc, 196, v0
    s_nop 1
    v_cndmask_b32 v49, 0, 1, vcc
    v_mul_u32_u24 v24, 9408, v49
    v_add_u32 v24, v24, v3
    v_add_u32 v24, 59136, v24
    s_waitcnt lgkmcnt(0)
    s_add_u32 s44, s44, 1
    s_bfe_u32 s48, s44, 0x30000
    s_bfe_u32 s49, s44, 0x30003
    s_lshl_b32 s49, s49, 16
    s_or_b32 s40, s48, s49
    s_bfe_u32 s48, s44, 0x30006
    s_bfe_u32 s49, s44, 0x30009
    s_lshl_b32 s49, s49, 16
    s_or_b32 s41, s48, s49
    s_bfe_u32 s48, s44, 0x3000c
    s_bfe_u32 s49, s44, 0x3000f
    s_lshl_b32 s49, s49, 16
    s_or_b32 s42, s48, s49
    s_bfe_u32 s48, s44, 0x30012
    s_bfe_u32 s49, s44, 0x30015
    s_lshl_b32 s49, s49, 16
    s_or_b32 s43, s48, s49
    s_cmp_ge_u32 s39, 4
    s_cbranch_scc1 L_xf4
    s_waitcnt vmcnt(2)
    s_branch L_xg5
L_xf4:
    s_waitcnt vmcnt(6)
L_xg5:
    v_lshlrev_b32 v48, 16, v4
    v_and_b32 v49, 0xffff0000, v4
    v_lshlrev_b32 v50, 16, v5
    v_and_b32 v51, 0xffff0000, v5
    v_lshlrev_b32 v52, 16, v6
    v_and_b32 v53, 0xffff0000, v6
    v_lshlrev_b32 v54, 16, v7
    v_and_b32 v55, 0xffff0000, v7
    v_readfirstlane_b32 s48, v48
    s_nop 1
    v_subrev_f32 v58, s48, v48
    v_subrev_f32 v59, s48, v49
    v_subrev_f32 v60, s48, v50
    v_subrev_f32 v61, s48, v51
    v_subrev_f32 v62, s48, v52
    v_subrev_f32 v63, s48, v53
    v_subrev_f32 v64, s48, v54
    v_subrev_f32 v65, s48, v55
    v_add_f32 v66, v58, v59
    v_mul_f32 v67, v58, v58
    v_fmac_f32 v67, v59, v59
    v_add_f32 v66, v66, v60
    v_fmac_f32 v67, v60, v60
    v_add_f32 v66, v66, v61
    v_fmac_f32 v67, v61, v61
    v_add_f32 v66, v66, v62
    v_fmac_f32 v67, v62, v62
    v_add_f32 v66, v66, v63
    v_fmac_f32 v67, v63, v63
    v_add_f32 v66, v66, v64
    v_fmac_f32 v67, v64, v64
    v_add_f32 v66, v66, v65
    v_fmac_f32 v67, v65, v65
    s_nop 0
    v_add_f32_dpp v66, v66, v66 row_ror:8 row_mask:0xf bank_mask:0xf
    v_add_f32_dpp v67, v67, v67 row_ror:8 row_mask:0xf bank_mask:0xf
    s_nop 0
    v_add_f32_dpp v66, v66, v66 row_ror:4 row_mask:0xf bank_mask:0xf
    v_add_f32_dpp v67, v67, v67 row_ror:4 row_mask:0xf bank_mask:0xf
    s_nop 0
    v_add_f32_dpp v66, v66, v66 row_ror:2 row_mask:0xf bank_mask:0xf
    v_add_f32_dpp v67, v67, v67 row_ror:2 row_mask:0xf bank_mask:0xf
    s_nop 0
    v_add_f32_dpp v66, v66, v66 row_ror:1 row_mask:0xf bank_mask:0xf
    v_add_f32_dpp v67, v67, v67 row_ror:1 row_mask:0xf bank_mask:0xf
    v_mov_b32 v68, v66
    v_mov_b32 v69, v67
    s_nop 0
    v_permlane16_swap_b32 v66, v68
    v_permlane16_swap_b32 v67, v69
    v_add_f32 v66, v66, v68
    v_add_f32 v67, v67, v69
    v_mov_b32 v68, v66
    v_mov_b32 v69, v67
    s_nop 0
    v_permlane32_swap_b32 v66, v68
    v_permlane32_swap_b32 v67, v69
    v_add_f32 v66, v66, v68
    v_add_f32 v67, v67, v69
    v_mul_f32 v66, 0x3b000000, v66
    v_mul_f32 v67, 0x3b000000, v67
    v_add_f32 v68, s48, v66
    v_fma_f32 v67, -v66, v66, v67
    v_max_f32 v67, 0, v67
    v_cvt_pk_bf16_f32 v68, v68, v67
    v_and_b32 v67, 0xffff0000, v68
    v_add_f32 v67, 0x3727c5ac, v67
    v_lshlrev_b32 v46, 16, v68
    v_cvt_pk_bf16_f32 v67, v67, v67
    v_lshlrev_b32 v67, 16, v67
    v_sqrt_f32 v67, v67
    s_nop 0
    v_cvt_pk_bf16_f32 v67, v67, v67
    v_lshlrev_b32 v67, 16, v67
    v_rcp_f32 v56, v67
    v_pk_add_f32 v[58:59], v[48:49], v[46:47] op_sel_hi:[1,0] neg_lo:[0,1] neg_hi:[0,1]
    v_pk_add_f32 v[60:61], v[50:51], v[46:47] op_sel_hi:[1,0] neg_lo:[0,1] neg_hi:[0,1]
    v_pk_add_f32 v[62:63], v[52:53], v[46:47] op_sel_hi:[1,0] neg_lo:[0,1] neg_hi:[0,1]
    v_pk_add_f32 v[64:65], v[54:55], v[46:47] op_sel_hi:[1,0] neg_lo:[0,1] neg_hi:[0,1]
    v_cvt_pk_bf16_f32 v66, v58, v59
    v_cvt_pk_bf16_f32 v67, v60, v61
    v_cvt_pk_bf16_f32 v68, v62, v63
    v_cvt_pk_bf16_f32 v69, v64, v65
    v_lshlrev_b32 v58, 16, v66
    v_and_b32 v59, 0xffff0000, v66
    v_lshlrev_b32 v60, 16, v67
    v_and_b32 v61, 0xffff0000, v67
    v_lshlrev_b32 v62, 16, v68
    v_and_b32 v63, 0xffff0000, v68
    v_lshlrev_b32 v64, 16, v69
    v_and_b32 v65, 0xffff0000, v69
    v_pk_mul_f32 v[58:59], v[58:59], v[56:57] op_sel_hi:[1,0]
    v_pk_mul_f32 v[60:61], v[60:61], v[56:57] op_sel_hi:[1,0]
    v_pk_mul_f32 v[62:63], v[62:63], v[56:57] op_sel_hi:[1,0]
    v_pk_mul_f32 v[64:65], v[64:65], v[56:57] op_sel_hi:[1,0]
    v_cvt_pk_bf16_f32 v8, v58, v59
    v_cvt_pk_bf16_f32 v9, v60, v61
    v_cvt_pk_bf16_f32 v10, v62, v63
    v_cvt_pk_bf16_f32 v11, v64, v65
    v_lshlrev_b32 v48, 16, v8
    v_and_b32 v49, 0xffff0000, v8
    v_lshlrev_b32 v50, 16, v9
    v_and_b32 v51, 0xffff0000, v9
    v_lshlrev_b32 v52, 16, v10
    v_and_b32 v53, 0xffff0000, v10
    v_lshlrev_b32 v54, 16, v11
    v_and_b32 v55, 0xffff0000, v11
    v_cvt_pk_f16_f32 v76, v48, v49
    v_cvt_pk_f16_f32 v77, v50, v51
    v_cvt_pk_f16_f32 v78, v52, v53
    v_cvt_pk_f16_f32 v79, v54, v55
    ds_write_b128 v36, v[76:79]
    v_mov_b32 v58, 0xfff8fff8
    s_cmp_ge_u32 s39, 4
    s_cbranch_scc1 L_p2k6
    v_lshrrev_b32 v49, 3, v0
    v_mul_u32_u24 v25, 80, v49
    v_bfe_u32 v50, v0, 1, 2
    v_lshlrev_b32 v51, 4, v50
    v_and_b32 v52, 1, v0
    v_mul_u32_u24 v53, 7680, v52
    v_add3_u32 v25, v25, v51, v53
    v_add_u32 v25, 86784, v25
    v_mul_u32_u24 v49, 144, v49
    v_lshlrev_b32 v50, 5, v50
    v_add_u32 v49, v49, v50
    v_mul_u32_u24 v29, 9216, v52
    v_add_u32 v29, v29, v49
    v_add_u32 v29, 108032, v29
    v_lshlrev_b32 v38, 1, v0
    v_add_u32 v38, 84224, v38
    s_lshl_b32 s48, s39, 10
    s_add_u32 s48, s48, 84224
    v_add_u32 v39, s48, v16
    s_cmp_ge_u32 s39, 4
    s_cbranch_scc1 L_pj7
    v_and_b32 v46, 31, v1
    v_lshrrev_b32 v47, 5, v1
    v_lshlrev_b32 v48, 4, v47
    v_and_b32 v26, 3, v46
    v_mul_u32_u24 v26, 3136, v26
    v_lshrrev_b32 v49, 2, v46
    v_lshlrev_b32 v49, 3, v49
    v_sub_u32 v26, v26, v49
    v_add_u32 v26, v26, v48
    v_mul_u32_u24 v28, 144, v46
    v_add_u32 v28, v28, v48
    s_lshr_b32 s48, s39, 1
    s_and_b32 s49, s39, 1
    s_mul_i32 s50, s48, 12544
    s_lshl_b32 s51, s49, 5
    s_add_u32 s50, s50, s51
    s_add_u32 s50, s50, 59208
    v_add_u32 v26, s50, v26
    v_mul_u32_u24 v27, 80, v46
    v_add_u32 v27, v27, v48
    s_mul_i32 s50, s48, 7680
    s_add_u32 s50, s50, s51
    s_add_u32 s50, s50, 84224
    v_add_u32 v27, s50, v27
    s_mul_i32 s50, s49, 18432
    s_mul_i32 s51, s48, 9216
    s_add_u32 s50, s50, s51
    s_add_u32 s50, s50, 108032
    v_add_u32 v28, s50, v28
    v_lshlrev_b32 v164, 3, v47
    v_bfe_u32 v49, v1, 2, 2
    v_add_u32 v164, v164, v49
    v_lshlrev_b32 v164, 6, v164
    v_bfe_u32 v49, v1, 4, 1
    v_lshlrev_b32 v49, 5, v49
    v_and_b32 v50, 3, v1
    v_lshlrev_b32 v50, 3, v50
    v_add3_u32 v164, v164, v49, v50
    s_mul_i32 s50, s48, 4224
    s_lshl_b32 s51, s49, 10
    s_add_u32 s50, s50, s51
    s_add_u32 s50, s50, 99584
    v_add_u32 v164, s50, v164
    s_lshl_b32 s50, s48, 3
    s_add_u32 s50, s50, 163328
    v_mov_b32 v162, s50
L_pj7:
L_p2k6:
    s_waitcnt lgkmcnt(0)
    s_barrier
    ds_read_b64_tr_b16 v[76:77], v37
    ds_read_b64_tr_b16 v[78:79], v37 offset:4352
    s_waitcnt lgkmcnt(0)
    v_and_or_b32 v76, v76, v58, s40
    v_and_or_b32 v77, v77, v58, s41
    v_and_or_b32 v78, v78, v58, s42
    v_and_or_b32 v79, v79, v58, s43
    global_store_dwordx4 v17, v[76:79], s[56:57] sc1
    s_lshl_b32 s48, s45, 16
    s_and_b32 s49, s45, 0xffff0000
    s_cmp_eq_u32 s52, 0
    s_cselect_b32 s48, s48, s49
    s_waitcnt vmcnt(1)
    v_mov_b32 v46, 0x3fb8aa3b
    v_mul_f32 v47, s48, v46
    v_mul_f32 v48, v40, v46
    v_exp_f32 v47, v47
    v_exp_f32 v48, v48
    s_nop 0
    v_cvt_pk_bf16_f32 v47, v47, v48
    v_and_b32 v48, 0xffff0000, v47
    v_lshlrev_b32 v47, 16, v47
    v_mul_f32 v49, v48, v47
    v_mul_f32 v50, v41, v47
    v_mul_f32 v49, 0xbfb8aa3b, v49
    v_mul_f32 v50, 0x3e22f983, v50
    s_cmp_ge_u32 s39, 4
    s_cbranch_scc1 L_grole8
    v_mul_f32 v60, 0x41800000, v49
    v_mul_f32 v61, 0x41800000, v50
    v_mul_f32 v63, 0x41000000, v49
    v_mul_f32 v64, 0x41000000, v50
    v_exp_f32 v60, v60
    v_fract_f32 v61, v61
    v_exp_f32 v63, v63
    v_fract_f32 v64, v64
    v_cos_f32 v62, v61
    v_sin_f32 v61, v61
    v_cos_f32 v65, v64
    v_sin_f32 v64, v64
    v_mul_f32 v52, v60, v62
    v_mul_f32 v53, v60, v61
    v_mul_f32 v56, v63, v65
    v_mul_f32 v57, v63, v64
    v_mov_b32 v54, 1.0
    v_mov_b32 v55, 0
    v_add_u32 v64, 12672, v18
    v_cvt_pk_f16_f32 v58, v54, v55
    v_cvt_pk_f16_f32 v59, v56, v57
    v_pk_mul_f32 v[60:61], v[54:55], v[52:53] op_sel:[0,0] op_sel_hi:[1,0]
    v_pk_mul_f32 v[62:63], v[56:57], v[52:53] op_sel:[0,0] op_sel_hi:[1,0]
    ds_write2_b32 v64, v58, v59 offset0:0 offset1:132
    v_pk_fma_f32 v[54:55], v[54:55], v[52:53], v[60:61] op_sel:[1,1,0] op_sel_hi:[0,1,1] neg_lo:[1,0,0]
    v_pk_fma_f32 v[56:57], v[56:57], v[52:53], v[62:63] op_sel:[1,1,0] op_sel_hi:[0,1,1] neg_lo:[1,0,0]
    v_add_u32 v64, 1056, v64
    v_cvt_pk_f16_f32 v58, v54, v55
    v_cvt_pk_f16_f32 v59, v56, v57
    v_pk_mul_f32 v[60:61], v[54:55], v[52:53] op_sel:[0,0] op_sel_hi:[1,0]
    v_pk_mul_f32 v[62:63], v[56:57], v[52:53] op_sel:[0,0] op_sel_hi:[1,0]
    ds_write2_b32 v64, v58, v59 offset0:0 offset1:132
    v_pk_fma_f32 v[54:55], v[54:55], v[52:53], v[60:61] op_sel:[1,1,0] op_sel_hi:[0,1,1] neg_lo:[1,0,0]
    v_pk_fma_f32 v[56:57], v[56:57], v[52:53], v[62:63] op_sel:[1,1,0] op_sel_hi:[0,1,1] neg_lo:[1,0,0]
    v_add_u32 v64, 1056, v64
    v_cvt_pk_f16_f32 v58, v54, v55
    v_cvt_pk_f16_f32 v59, v56, v57
    v_pk_mul_f32 v[60:61], v[54:55], v[52:53] op_sel:[0,0] op_sel_hi:[1,0]
    v_pk_mul_f32 v[62:63], v[56:57], v[52:53] op_sel:[0,0] op_sel_hi:[1,0]
    ds_write2_b32 v64, v58, v59 offset0:0 offset1:132
    v_pk_fma_f32 v[54:55], v[54:55], v[52:53], v[60:61] op_sel:[1,1,0] op_sel_hi:[0,1,1] neg_lo:[1,0,0]
    v_pk_fma_f32 v[56:57], v[56:57], v[52:53], v[62:63] op_sel:[1,1,0] op_sel_hi:[0,1,1] neg_lo:[1,0,0]
    v_add_u32 v64, 1056, v64
    v_cvt_pk_f16_f32 v58, v54, v55
    v_cvt_pk_f16_f32 v59, v56, v57
    v_pk_mul_f32 v[60:61], v[54:55], v[52:53] op_sel:[0,0] op_sel_hi:[1,0]
    v_pk_mul_f32 v[62:63], v[56:57], v[52:53] op_sel:[0,0] op_sel_hi:[1,0]
    ds_write2_b32 v64, v58, v59 offset0:0 offset1:132
    v_pk_fma_f32 v[54:55], v[54:55], v[52:53], v[60:61] op_sel:[1,1,0] op_sel_hi:[0,1,1] neg_lo:[1,0,0]
    v_pk_fma_f32 v[56:57], v[56:57], v[52:53], v[62:63] op_sel:[1,1,0] op_sel_hi:[0,1,1] neg_lo:[1,0,0]
    v_add_u32 v64, 1056, v64
    v_cvt_pk_f16_f32 v58, v54, v55
    v_cvt_pk_f16_f32 v59, v56, v57
    v_pk_mul_f32 v[60:61], v[54:55], v[52:53] op_sel:[0,0] op_sel_hi:[1,0]
    v_pk_mul_f32 v[62:63], v[56:57], v[52:53] op_sel:[0,0] op_sel_hi:[1,0]
    ds_write2_b32 v64, v58, v59 offset0:0 offset1:132
    v_pk_fma_f32 v[54:55], v[54:55], v[52:53], v[60:61] op_sel:[1,1,0] op_sel_hi:[0,1,1] neg_lo:[1,0,0]
    v_pk_fma_f32 v[56:57], v[56:57], v[52:53], v[62:63] op_sel:[1,1,0] op_sel_hi:[0,1,1] neg_lo:[1,0,0]
    v_add_u32 v64, 1056, v64
    v_cvt_pk_f16_f32 v58, v54, v55
    v_cvt_pk_f16_f32 v59, v56, v57
    v_pk_mul_f32 v[60:61], v[54:55], v[52:53] op_sel:[0,0] op_sel_hi:[1,0]
    v_pk_mul_f32 v[62:63], v[56:57], v[52:53] op_sel:[0,0] op_sel_hi:[1,0]
    ds_write2_b32 v64, v58, v59 offset0:0 offset1:132
    v_pk_fma_f32 v[54:55], v[54:55], v[52:53], v[60:61] op_sel:[1,1,0] op_sel_hi:[0,1,1] neg_lo:[1,0,0]
    v_pk_fma_f32 v[56:57], v[56:57], v[52:53], v[62:63] op_sel:[1,1,0] op_sel_hi:[0,1,1] neg_lo:[1,0,0]
    v_add_u32 v64, 1056, v64
    v_cvt_pk_f16_f32 v58, v54, v55
    v_cvt_pk_f16_f32 v59, v56, v57
    v_pk_mul_f32 v[60:61], v[54:55], v[52:53] op_sel:[0,0] op_sel_hi:[1,0]
    v_pk_mul_f32 v[62:63], v[56:57], v[52:53] op_sel:[0,0] op_sel_hi:[1,0]
    ds_write2_b32 v64, v58, v59 offset0:0 offset1:132
    v_pk_fma_f32 v[54:55], v[54:55], v[52:53], v[60:61] op_sel:[1,1,0] op_sel_hi:[0,1,1] neg_lo:[1,0,0]
    v_pk_fma_f32 v[56:57], v[56:57], v[52:53], v[62:63] op_sel:[1,1,0] op_sel_hi:[0,1,1] neg_lo:[1,0,0]
    v_add_u32 v64, 1056, v64
    v_cvt_pk_f16_f32 v58, v54, v55
    v_cvt_pk_f16_f32 v59, v56, v57
    v_pk_mul_f32 v[60:61], v[54:55], v[52:53] op_sel:[0,0] op_sel_hi:[1,0]
    v_pk_mul_f32 v[62:63], v[56:57], v[52:53] op_sel:[0,0] op_sel_hi:[1,0]
    ds_write2_b32 v64, v58, v59 offset0:0 offset1:132
    v_pk_fma_f32 v[54:55], v[54:55], v[52:53], v[60:61] op_sel:[1,1,0] op_sel_hi:[0,1,1] neg_lo:[1,0,0]
    v_pk_fma_f32 v[56:57], v[56:57], v[52:53], v[62:63] op_sel:[1,1,0] op_sel_hi:[0,1,1] neg_lo:[1,0,0]
    v_add_u32 v64, 1056, v64
    v_cvt_pk_f16_f32 v58, v54, v55
    v_cvt_pk_f16_f32 v59, v56, v57
    v_pk_mul_f32 v[60:61], v[54:55], v[52:53] op_sel:[0,0] op_sel_hi:[1,0]
    v_pk_mul_f32 v[62:63], v[56:57], v[52:53] op_sel:[0,0] op_sel_hi:[1,0]
    ds_write2_b32 v64, v58, v59 offset0:0 offset1:132
    v_pk_fma_f32 v[54:55], v[54:55], v[52:53], v[60:61] op_sel:[1,1,0] op_sel_hi:[0,1,1] neg_lo:[1,0,0]
    v_pk_fma_f32 v[56:57], v[56:57], v[52:53], v[62:63] op_sel:[1,1,0] op_sel_hi:[0,1,1] neg_lo:[1,0,0]
    v_add_u32 v64, 1056, v64
    v_cvt_pk_f16_f32 v58, v54, v55
    v_cvt_pk_f16_f32 v59, v56, v57
    v_pk_mul_f32 v[60:61], v[54:55], v[52:53] op_sel:[0,0] op_sel_hi:[1,0]
    v_pk_mul_f32 v[62:63], v[56:57], v[52:53] op_sel:[0,0] op_sel_hi:[1,0]
    ds_write2_b32 v64, v58, v59 offset0:0 offset1:132
    v_pk_fma_f32 v[54:55], v[54:55], v[52:53], v[60:61] op_sel:[1,1,0] op_sel_hi:[0,1,1] neg_lo:[1,0,0]
    v_pk_fma_f32 v[56:57], v[56:57], v[52:53], v[62:63] op_sel:[1,1,0] op_sel_hi:[0,1,1] neg_lo:[1,0,0]
    v_add_u32 v64, 1056, v64
    v_cvt_pk_f16_f32 v58, v54, v55
    v_cvt_pk_f16_f32 v59, v56, v57
    v_pk_mul_f32 v[60:61], v[54:55], v[52:53] op_sel:[0,0] op_sel_hi:[1,0]
    v_pk_mul_f32 v[62:63], v[56:57], v[52:53] op_sel:[0,0] op_sel_hi:[1,0]
    ds_write2_b32 v64, v58, v59 offset0:0 offset1:132
    v_pk_fma_f32 v[54:55], v[54:55], v[52:53], v[60:61] op_sel:[1,1,0] op_sel_hi:[0,1,1] neg_lo:[1,0,0]
    v_pk_fma_f32 v[56:57], v[56:57], v[52:53], v[62:63] op_sel:[1,1,0] op_sel_hi:[0,1,1] neg_lo:[1,0,0]
    v_add_u32 v64, 1056, v64
    v_cvt_pk_f16_f32 v58, v54, v55
    v_cvt_pk_f16_f32 v59, v56, v57
    v_pk_mul_f32 v[60:61], v[54:55], v[52:53] op_sel:[0,0] op_sel_hi:[1,0]
    v_pk_mul_f32 v[62:63], v[56:57], v[52:53] op_sel:[0,0] op_sel_hi:[1,0]
    ds_write2_b32 v64, v58, v59 offset0:0 offset1:132
    v_pk_fma_f32 v[54:55], v[54:55], v[52:53], v[60:61] op_sel:[1,1,0] op_sel_hi:[0,1,1] neg_lo:[1,0,0]
    v_pk_fma_f32 v[56:57], v[56:57], v[52:53], v[62:63] op_sel:[1,1,0] op_sel_hi:[0,1,1] neg_lo:[1,0,0]
    v_add_u32 v64, 1056, v64
    v_cvt_pk_f16_f32 v58, v54, v55
    v_cvt_pk_f16_f32 v59, v56, v57
    v_pk_mul_f32 v[60:61], v[54:55], v[52:53] op_sel:[0,0] op_sel_hi:[1,0]
    v_pk_mul_f32 v[62:63], v[56:57], v[52:53] op_sel:[0,0] op_sel_hi:[1,0]
    ds_write2_b32 v64, v58, v59 offset0:0 offset1:132
    v_pk_fma_f32 v[54:55], v[54:55], v[52:53], v[60:61] op_sel:[1,1,0] op_sel_hi:[0,1,1] neg_lo:[1,0,0]
    v_pk_fma_f32 v[56:57], v[56:57], v[52:53], v[62:63] op_sel:[1,1,0] op_sel_hi:[0,1,1] neg_lo:[1,0,0]
    v_add_u32 v64, 1056, v64
    v_cvt_pk_f16_f32 v58, v54, v55
    v_cvt_pk_f16_f32 v59, v56, v57
    v_pk_mul_f32 v[60:61], v[54:55], v[52:53] op_sel:[0,0] op_sel_hi:[1,0]
    v_pk_mul_f32 v[62:63], v[56:57], v[52:53] op_sel:[0,0] op_sel_hi:[1,0]
    ds_write2_b32 v64, v58, v59 offset0:0 offset1:132
    v_pk_fma_f32 v[54:55], v[54:55], v[52:53], v[60:61] op_sel:[1,1,0] op_sel_hi:[0,1,1] neg_lo:[1,0,0]
    v_pk_fma_f32 v[56:57], v[56:57], v[52:53], v[62:63] op_sel:[1,1,0] op_sel_hi:[0,1,1] neg_lo:[1,0,0]
    v_add_u32 v64, 1056, v64
    v_cvt_pk_f16_f32 v58, v54, v55
    v_cvt_pk_f16_f32 v59, v56, v57
    v_pk_mul_f32 v[60:61], v[54:55], v[52:53] op_sel:[0,0] op_sel_hi:[1,0]
    v_pk_mul_f32 v[62:63], v[56:57], v[52:53] op_sel:[0,0] op_sel_hi:[1,0]
    ds_write2_b32 v64, v58, v59 offset0:0 offset1:132
    v_pk_fma_f32 v[54:55], v[54:55], v[52:53], v[60:61] op_sel:[1,1,0] op_sel_hi:[0,1,1] neg_lo:[1,0,0]
    v_pk_fma_f32 v[56:57], v[56:57], v[52:53], v[62:63] op_sel:[1,1,0] op_sel_hi:[0,1,1] neg_lo:[1,0,0]
    v_add_u32 v64, 1056, v64
    v_cvt_pk_f16_f32 v58, v54, v55
    v_cvt_pk_f16_f32 v59, v56, v57
    ds_write2_b32 v64, v58, v59 offset0:0 offset1:132
    s_branch L_tabdone9
L_grole8:
    v_mov_b32 v60, v49
    v_fract_f32 v61, v50
    v_mul_f32 v63, 0x43800000, v49
    v_mul_f32 v64, 0x43800000, v50
    v_exp_f32 v60, v60
    v_exp_f32 v63, v63
    v_fract_f32 v64, v64
    v_cos_f32 v62, v61
    v_sin_f32 v61, v61
    v_cos_f32 v65, v64
    v_sin_f32 v64, v64
    v_mul_f32 v52, v60, v62
    v_mul_f32 v53, v60, v61
    v_mul_f32 v54, v63, v65
    v_mul_f32 v55, v63, v64
    v_mul_f32 v42, v42, v47
    v_mul_f32 v43, v43, v47
    v_mul_f32 v44, v44, v47
    v_mul_f32 v45, v45, v47
    v_max3_f32 v46, |v42|, |v43|, |v44|
    v_max_f32 v46, v46, |v45|
    v_pk_mul_f32 v[66:67], v[52:53], v[52:53] op_sel:[0,0] op_sel_hi:[1,0]
    v_pk_fma_f32 v[56:57], v[52:53], v[52:53], v[66:67] op_sel:[1,1,0] op_sel_hi:[0,1,1] neg_lo:[1,0,0]
    v_max_f32_dpp v46, v46, v46 row_ror:8 row_mask:0xf bank_mask:0xf
    s_nop 1
    v_max_f32_dpp v46, v46, v46 row_ror:4 row_mask:0xf bank_mask:0xf
    s_nop 1
    v_max_f32_dpp v46, v46, v46 row_ror:2 row_mask:0xf bank_mask:0xf
    s_nop 1
    v_max_f32_dpp v46, v46, v46 row_ror:1 row_mask:0xf bank_mask:0xf
    v_mov_b32 v47, v46
    s_nop 1
    v_permlane16_swap_b32 v46, v47
    v_max_f32 v46, v46, v47
    v_mov_b32 v47, v46
    s_nop 1
    v_permlane32_swap_b32 v46, v47
    v_max_f32 v46, v46, v47
    v_pk_mul_f32 v[66:67], v[56:57], v[56:57] op_sel:[0,0] op_sel_hi:[1,0]
    v_pk_fma_f32 v[58:59], v[56:57], v[56:57], v[66:67] op_sel:[1,1,0] op_sel_hi:[0,1,1] neg_lo:[1,0,0]
    v_frexp_exp_i32_f32 v46, v46
    v_pk_mul_f32 v[66:67], v[58:59], v[58:59] op_sel:[0,0] op_sel_hi:[1,0]
    v_pk_fma_f32 v[60:61], v[58:59], v[58:59], v[66:67] op_sel:[1,1,0] op_sel_hi:[0,1,1] neg_lo:[1,0,0]
    v_sub_u32 v47, 0, v46
    v_ldexp_f32 v62, v42, v47
    v_ldexp_f32 v63, v43, v47
    v_add_u32 v46, 1, v46
    v_ldexp_f32 v46, 1.0, v46
    s_bitcmp1_b32 s39, 0
    s_cbranch_scc1 L_nosc10
    s_lshl_b32 s48, s38, 1
    s_add_u32 s48, s48, s52
    s_lshl_b32 s48, s48, 3
    s_add_u32 s48, s48, 4366336
    v_mov_b32 v80, s48
    v_mul_f32 v78, 0x44000000, v46
    v_mov_b32 v79, s44
    s_mov_b64 exec, 1
    global_store_dwordx2 v80, v[78:79], s[36:37] sc1
    s_mov_b64 exec, -1
L_nosc10:
    v_mov_b32 v74, v18
    v_add_u32 v75, 4224, v18
    v_pk_mul_f32 v[70:71], v[62:63], v[54:55] op_sel:[0,0] op_sel_hi:[1,0]
    v_pk_fma_f32 v[64:65], v[62:63], v[54:55], v[70:71] op_sel:[1,1,0] op_sel_hi:[0,1,1] neg_lo:[1,0,0]
    v_cvt_pk_f16_f32 v76, v64, -v65
    v_pk_mul_f32 v[70:71], v[64:65], v[56:57] op_sel:[0,0] op_sel_hi:[1,0]
    v_pk_fma_f32 v[68:69], v[64:65], v[56:57], v[70:71] op_sel:[1,1,0] op_sel_hi:[0,1,1] neg_lo:[1,0,0]
    v_cvt_pk_f16_f32 v77, v68, -v69
    ds_write2_b32 v75, v76, v77 offset0:0 offset1:132
    v_add_u32 v75, 1056, v75
    v_cvt_pk_f16_f32 v72, v62, -v63
    v_pk_mul_f32 v[70:71], v[68:69], v[56:57] op_sel:[0,0] op_sel_hi:[1,0]
    v_pk_fma_f32 v[68:69], v[68:69], v[56:57], v[70:71] op_sel:[1,1,0] op_sel_hi:[0,1,1] neg_lo:[1,0,0]
    v_cvt_pk_f16_f32 v76, v68, -v69
    v_pk_mul_f32 v[70:71], v[68:69], v[56:57] op_sel:[0,0] op_sel_hi:[1,0]
    v_pk_fma_f32 v[68:69], v[68:69], v[56:57], v[70:71] op_sel:[1,1,0] op_sel_hi:[0,1,1] neg_lo:[1,0,0]
    v_cvt_pk_f16_f32 v77, v68, -v69
    ds_write2_b32 v75, v76, v77 offset0:0 offset1:132
    v_add_u32 v75, 1056, v75
    v_pk_mul_f32 v[66:67], v[62:63], v[52:53] op_sel:[0,0] op_sel_hi:[1,0]
    v_pk_fma_f32 v[62:63], v[62:63], v[52:53], v[66:67] op_sel:[1,1,0] op_sel_hi:[0,1,1] neg_lo:[1,0,0]
    v_cvt_pk_f16_f32 v73, v62, -v63
    ds_write2_b32 v74, v72, v73 offset0:0 offset1:132
    v_add_u32 v74, 1056, v74
    v_pk_mul_f32 v[70:71], v[68:69], v[56:57] op_sel:[0,0] op_sel_hi:[1,0]
    v_pk_fma_f32 v[68:69], v[68:69], v[56:57], v[70:71] op_sel:[1,1,0] op_sel_hi:[0,1,1] neg_lo:[1,0,0]
    v_cvt_pk_f16_f32 v76, v68, -v69
    v_pk_mul_f32 v[70:71], v[64:65], v[54:55] op_sel:[0,0] op_sel_hi:[1,0]
    v_pk_fma_f32 v[64:65], v[64:65], v[54:55], v[70:71] op_sel:[1,1,0] op_sel_hi:[0,1,1] neg_lo:[1,0,0]
    v_cvt_pk_f16_f32 v77, v64, -v65
    ds_write2_b32 v75, v76, v77 offset0:0 offset1:132
    v_add_u32 v75, 1056, v75
    v_pk_mul_f32 v[66:67], v[62:63], v[52:53] op_sel:[0,0] op_sel_hi:[1,0]
    v_pk_fma_f32 v[62:63], v[62:63], v[52:53], v[66:67] op_sel:[1,1,0] op_sel_hi:[0,1,1] neg_lo:[1,0,0]
    v_cvt_pk_f16_f32 v72, v62, -v63
    v_pk_mul_f32 v[70:71], v[64:65], v[58:59] op_sel:[0,0] op_sel_hi:[1,0]
    v_pk_fma_f32 v[68:69], v[64:65], v[58:59], v[70:71] op_sel:[1,1,0] op_sel_hi:[0,1,1] neg_lo:[1,0,0]
    v_cvt_pk_f16_f32 v76, v68, -v69
    v_pk_mul_f32 v[70:71], v[68:69], v[58:59] op_sel:[0,0] op_sel_hi:[1,0]
    v_pk_fma_f32 v[68:69], v[68:69], v[58:59], v[70:71] op_sel:[1,1,0] op_sel_hi:[0,1,1] neg_lo:[1,0,0]
    v_cvt_pk_f16_f32 v77, v68, -v69
    ds_write2_b32 v75, v76, v77 offset0:0 offset1:132
    v_add_u32 v75, 1056, v75
    v_pk_mul_f32 v[66:67], v[62:63], v[52:53] op_sel:[0,0] op_sel_hi:[1,0]
    v_pk_fma_f32 v[62:63], v[62:63], v[52:53], v[66:67] op_sel:[1,1,0] op_sel_hi:[0,1,1] neg_lo:[1,0,0]
    v_cvt_pk_f16_f32 v73, v62, -v63
    ds_write2_b32 v74, v72, v73 offset0:0 offset1:132
    v_add_u32 v74, 1056, v74
    v_pk_mul_f32 v[70:71], v[64:65], v[54:55] op_sel:[0,0] op_sel_hi:[1,0]
    v_pk_fma_f32 v[64:65], v[64:65], v[54:55], v[70:71] op_sel:[1,1,0] op_sel_hi:[0,1,1] neg_lo:[1,0,0]
    v_cvt_pk_f16_f32 v76, v64, -v65
    v_pk_mul_f32 v[70:71], v[64:65], v[58:59] op_sel:[0,0] op_sel_hi:[1,0]
    v_pk_fma_f32 v[68:69], v[64:65], v[58:59], v[70:71] op_sel:[1,1,0] op_sel_hi:[0,1,1] neg_lo:[1,0,0]
    v_cvt_pk_f16_f32 v77, v68, -v69
    ds_write2_b32 v75, v76, v77 offset0:0 offset1:132
    v_add_u32 v75, 1056, v75
    v_pk_mul_f32 v[66:67], v[62:63], v[52:53] op_sel:[0,0] op_sel_hi:[1,0]
    v_pk_fma_f32 v[62:63], v[62:63], v[52:53], v[66:67] op_sel:[1,1,0] op_sel_hi:[0,1,1] neg_lo:[1,0,0]
    v_cvt_pk_f16_f32 v72, v62, -v63
    v_pk_mul_f32 v[70:71], v[68:69], v[58:59] op_sel:[0,0] op_sel_hi:[1,0]
    v_pk_fma_f32 v[68:69], v[68:69], v[58:59], v[70:71] op_sel:[1,1,0] op_sel_hi:[0,1,1] neg_lo:[1,0,0]
    v_cvt_pk_f16_f32 v76, v68, -v69
    v_pk_mul_f32 v[70:71], v[64:65], v[54:55] op_sel:[0,0] op_sel_hi:[1,0]
    v_pk_fma_f32 v[64:65], v[64:65], v[54:55], v[70:71] op_sel:[1,1,0] op_sel_hi:[0,1,1] neg_lo:[1,0,0]
    v_cvt_pk_f16_f32 v77, v64, -v65
    ds_write2_b32 v75, v76, v77 offset0:0 offset1:132
    v_add_u32 v75, 1056, v75
    v_pk_mul_f32 v[66:67], v[62:63], v[52:53] op_sel:[0,0] op_sel_hi:[1,0]
    v_pk_fma_f32 v[62:63], v[62:63], v[52:53], v[66:67] op_sel:[1,1,0] op_sel_hi:[0,1,1] neg_lo:[1,0,0]
    v_cvt_pk_f16_f32 v73, v62, -v63
    ds_write2_b32 v74, v72, v73 offset0:0 offset1:132
    v_add_u32 v74, 1056, v74
    v_pk_mul_f32 v[70:71], v[64:65], v[60:61] op_sel:[0,0] op_sel_hi:[1,0]
    v_pk_fma_f32 v[64:65], v[64:65], v[60:61], v[70:71] op_sel:[1,1,0] op_sel_hi:[0,1,1] neg_lo:[1,0,0]
    v_cvt_pk_f16_f32 v76, v64, -v65
    v_pk_mul_f32 v[70:71], v[64:65], v[54:55] op_sel:[0,0] op_sel_hi:[1,0]
    v_pk_fma_f32 v[64:65], v[64:65], v[54:55], v[70:71] op_sel:[1,1,0] op_sel_hi:[0,1,1] neg_lo:[1,0,0]
    v_cvt_pk_f16_f32 v77, v64, -v65
    ds_write2_b32 v75, v76, v77 offset0:0 offset1:132
    v_add_u32 v75, 1056, v75
    v_pk_mul_f32 v[66:67], v[62:63], v[52:53] op_sel:[0,0] op_sel_hi:[1,0]
    v_pk_fma_f32 v[62:63], v[62:63], v[52:53], v[66:67] op_sel:[1,1,0] op_sel_hi:[0,1,1] neg_lo:[1,0,0]
    v_cvt_pk_f16_f32 v72, v62, -v63
    v_pk_mul_f32 v[70:71], v[64:65], v[54:55] op_sel:[0,0] op_sel_hi:[1,0]
    v_pk_fma_f32 v[64:65], v[64:65], v[54:55], v[70:71] op_sel:[1,1,0] op_sel_hi:[0,1,1] neg_lo:[1,0,0]
    v_cvt_pk_f16_f32 v76, v64, -v65
    v_pk_mul_f32 v[70:71], v[64:65], v[54:55] op_sel:[0,0] op_sel_hi:[1,0]
    v_pk_fma_f32 v[64:65], v[64:65], v[54:55], v[70:71] op_sel:[1,1,0] op_sel_hi:[0,1,1] neg_lo:[1,0,0]
    v_cvt_pk_f16_f32 v77, v64, -v65
    ds_write2_b32 v75, v76, v77 offset0:0 offset1:132
    v_pk_mul_f32 v[66:67], v[62:63], v[52:53] op_sel:[0,0] op_sel_hi:[1,0]
    v_pk_fma_f32 v[62:63], v[62:63], v[52:53], v[66:67] op_sel:[1,1,0] op_sel_hi:[0,1,1] neg_lo:[1,0,0]
    v_cvt_pk_f16_f32 v73, v62, -v63
    ds_write2_b32 v74, v72, v73 offset0:0 offset1:132
L_tabdone9:
    s_waitcnt lgkmcnt(0)
    s_barrier
    s_bfe_u32 s53, s39, 0x10001
    s_and_b32 s54, s39, 1
    ds_read_b128 v[80:83], v19 offset:0
    ds_read_b128 v[112:115], v20 offset:0
    ds_read_b128 v[84:87], v19 offset:16
    ds_read_b128 v[116:119], v20 offset:16
    ds_read_b128 v[88:91], v19 offset:32
    ds_read_b128 v[120:123], v20 offset:32
    ds_read_b128 v[92:95], v19 offset:48
    ds_read_b128 v[124:127], v20 offset:48
    ds_read_b128 v[96:99], v19 offset:64
    ds_read_b128 v[128:131], v20 offset:64
    ds_read_b128 v[100:103], v19 offset:80
    ds_read_b128 v[132:135], v20 offset:80
    ds_read_b128 v[104:107], v19 offset:96
    ds_read_b128 v[136:139], v20 offset:96
    ds_read_b128 v[108:111], v19 offset:112
    ds_read_b128 v[140:143], v20 offset:112
    s_cmp_ge_u32 s39, 4
    s_cbranch_scc0 L_p2t11
    v_lshrrev_b32 v49, 3, v0
    v_mul_u32_u24 v25, 80, v49
    v_bfe_u32 v50, v0, 1, 2
    v_lshlrev_b32 v51, 4, v50
    v_and_b32 v52, 1, v0
    v_mul_u32_u24 v53, 7680, v52
    v_add3_u32 v25, v25, v51, v53
    v_add_u32 v25, 86784, v25
    v_mul_u32_u24 v49, 144, v49
    v_lshlrev_b32 v50, 5, v50
    v_add_u32 v49, v49, v50
    v_mul_u32_u24 v29, 9216, v52
    v_add_u32 v29, v29, v49
    v_add_u32 v29, 108032, v29
    v_lshlrev_b32 v38, 1, v0
    v_add_u32 v38, 84224, v38
    s_lshl_b32 s48, s39, 10
    s_add_u32 s48, s48, 84224
    v_add_u32 v39, s48, v16
    s_cmp_ge_u32 s39, 4
    s_cbranch_scc1 L_pj12
    v_and_b32 v46, 31, v1
    v_lshrrev_b32 v47, 5, v1
    v_lshlrev_b32 v48, 4, v47
    v_and_b32 v26, 3, v46
    v_mul_u32_u24 v26, 3136, v26
    v_lshrrev_b32 v49, 2, v46
    v_lshlrev_b32 v49, 3, v49
    v_sub_u32 v26, v26, v49
    v_add_u32 v26, v26, v48
    v_mul_u32_u24 v28, 144, v46
    v_add_u32 v28, v28, v48
    s_lshr_b32 s48, s39, 1
    s_and_b32 s49, s39, 1
    s_mul_i32 s50, s48, 12544
    s_lshl_b32 s51, s49, 5
    s_add_u32 s50, s50, s51
    s_add_u32 s50, s50, 59208
    v_add_u32 v26, s50, v26
    v_mul_u32_u24 v27, 80, v46
    v_add_u32 v27, v27, v48
    s_mul_i32 s50, s48, 7680
    s_add_u32 s50, s50, s51
    s_add_u32 s50, s50, 84224
    v_add_u32 v27, s50, v27
    s_mul_i32 s50, s49, 18432
    s_mul_i32 s51, s48, 9216
    s_add_u32 s50, s50, s51
    s_add_u32 s50, s50, 108032
    v_add_u32 v28, s50, v28
    v_lshlrev_b32 v164, 3, v47
    v_bfe_u32 v49, v1, 2, 2
    v_add_u32 v164, v164, v49
    v_lshlrev_b32 v164, 6, v164
    v_bfe_u32 v49, v1, 4, 1
    v_lshlrev_b32 v49, 5, v49
    v_and_b32 v50, 3, v1
    v_lshlrev_b32 v50, 3, v50
    v_add3_u32 v164, v164, v49, v50
    s_mul_i32 s50, s48, 4224
    s_lshl_b32 s51, s49, 10
    s_add_u32 s50, s50, s51
    s_add_u32 s50, s50, 99584
    v_add_u32 v164, s50, v164
    s_lshl_b32 s50, s48, 3
    s_add_u32 s50, s50, 163328
    v_mov_b32 v162, s50
L_pj12:
    s_bfe_u32 s53, s39, 0x10001
    s_and_b32 s54, s39, 1
L_p2t11:
    s_waitcnt lgkmcnt(14)
    v_mfma_f32_16x16x32_f16 v[52:55], v[112:115], v[80:83], 0
    s_waitcnt lgkmcnt(12)
    v_mfma_f32_16x16x32_f16 v[52:55], v[116:119], v[84:87], v[52:55]
    s_waitcnt lgkmcnt(10)
    v_mfma_f32_16x16x32_f16 v[52:55], v[120:123], v[88:91], v[52:55]
    s_waitcnt lgkmcnt(8)
    v_mfma_f32_16x16x32_f16 v[52:55], v[124:127], v[92:95], v[52:55]
    s_waitcnt lgkmcnt(6)
    v_mfma_f32_16x16x32_f16 v[52:55], v[128:131], v[96:99], v[52:55]
    s_waitcnt lgkmcnt(4)
    v_mfma_f32_16x16x32_f16 v[52:55], v[132:135], v[100:103], v[52:55]
    s_waitcnt lgkmcnt(2)
    v_mfma_f32_16x16x32_f16 v[52:55], v[136:139], v[104:107], v[52:55]
    s_waitcnt lgkmcnt(0)
    v_mfma_f32_16x16x32_f16 v[52:55], v[140:143], v[108:111], v[52:55]
    global_load_dwordx4 v[72:75], v2, s[56:57] sc1
    s_cmp_eq_u32 s53, 0
    s_cbranch_scc0 L_ke113
    s_mov_b32 vcc_lo, -1
    s_mov_b32 vcc_hi, 0
    s_nop 2
    v_cndmask_b32 v55, v54, v55, vcc
    v_cvt_pk_f16_f32 v60, v52, v53
    v_cvt_pk_f16_f32 v61, v54, v55
    ds_write_b64 v22, v[60:61]
    s_branch L_kej14
L_ke113:
    s_nop 7
    v_cvt_pk_f16_f32 v60, v52, v52
    v_cvt_pk_f16_f32 v61, v53, v53
    v_cvt_pk_f16_f32 v62, v53, v54
    v_cvt_pk_f16_f32 v63, v54, v54
    v_cvt_pk_f16_f32 v64, v52, v53
    v_cvt_pk_f16_f32 v65, v54, v55
    s_mov_b32 exec_hi, 0
    ds_write_b128 v22, v[60:63]
    s_mov_b32 exec_lo, 0
    s_mov_b32 exec_hi, 0xffff
    ds_write_b16 v23, v64 offset:48
    ds_write_b16_d16_hi v23, v64 offset:32
    ds_write_b16 v23, v65 offset:16
    ds_write_b16_d16_hi v23, v65
    s_cmp_eq_u32 s54, 0
    s_cbranch_scc0 L_KE_NOF
    s_mov_b32 exec_hi, 0x10000
    ds_write_b16 v31, v60 offset:134
    ds_write_b32 v31, v60 offset:136
    ds_write_b32 v31, v60 offset:140
L_KE_NOF:
    s_mov_b64 exec, -1
L_kej14:
    s_waitcnt lgkmcnt(0)
    s_barrier
    v_cmp_gt_u32 vcc, 392, v0
    s_nop 0
    s_and_saveexec_b64 s[50:51], vcc
    ds_read_b128 v[44:47], v24 offset:9408
    ds_read_b64 v[48:49], v24 offset:9424
    s_waitcnt lgkmcnt(0)
    v_alignbit_b32 v52, v45, v44, 16
    v_alignbit_b32 v53, v46, v45, 16
    v_alignbit_b32 v54, v47, v46, 16
    v_alignbit_b32 v55, v48, v47, 16
    ds_write_b128 v24, v[52:55] offset:6272
    v_mov_b32 v56, v45
    v_mov_b32 v57, v46
    v_mov_b32 v58, v47
    v_mov_b32 v59, v48
    ds_write_b128 v24, v[56:59] offset:3136
    v_alignbit_b32 v60, v46, v45, 16
    v_alignbit_b32 v61, v47, v46, 16
    v_alignbit_b32 v62, v48, v47, 16
    v_alignbit_b32 v63, v49, v48, 16
    ds_write_b128 v24, v[60:63]
    s_mov_b64 exec, s[50:51]
    v_mov_b32 v64, 0x00070007
    v_mov_b32 v65, 0x7c007c00
    v_mov_b32 v66, 0x4c004c00
    v_mov_b32 v67, 0xfff8fff8
    s_mov_b32 s55, 0
L_h1p15:
    s_waitcnt vmcnt(0)
    v_xor_b32 v68, s40, v72
    v_xor_b32 v69, s41, v73
    v_xor_b32 v70, s42, v74
    v_xor_b32 v71, s43, v75
    v_and_b32 v68, v68, v64
    v_and_or_b32 v68, v69, v64, v68
    v_and_or_b32 v68, v70, v64, v68
    v_and_or_b32 v68, v71, v64, v68
    v_and_b32 v76, v72, v65
    v_and_b32 v77, v73, v65
    v_and_b32 v78, v74, v65
    v_and_b32 v79, v75, v65
    v_pk_max_u16 v76, v76, v77
    v_pk_max_u16 v78, v78, v79
    v_pk_max_u16 v76, v76, v66
    v_pk_max_u16 v76, v76, v78
    v_xor_b32 v76, v76, v66
    v_or_b32 v68, v68, v76
    v_cmp_ne_u32 vcc, 0, v68
    s_cbranch_vccz L_h1ok16
    s_add_u32 s55, s55, 1
    s_cmp_lt_u32 s55, 0x20000
    s_cbranch_scc0 L_h1ok16
    s_and_b64 exec, exec, vcc
    s_sleep 4
    global_load_dwordx4 v[72:75], v2, s[56:57] sc1
    s_branch L_h1p15
L_h1ok16:
    s_mov_b64 exec, -1
    v_and_b32 v72, v72, v67
    v_and_b32 v73, v73, v67
    v_and_b32 v74, v74, v67
    v_and_b32 v75, v75, v67
    ds_write_b128 v25, v[72:75]
    s_waitcnt lgkmcnt(0)
    s_barrier
    s_cmp_eq_u32 s38, 0
    s_cbranch_scc0 L_noep17
    s_cmp_eq_u32 s39, 6
    s_cbranch_scc0 L_noep17
    v_mov_b32 v68, 0
    v_mov_b32 v69, s44
    s_mov_b64 exec, 1
    global_store_dword v68, v69, s[36:37] sc1
    s_mov_b64 exec, -1
L_noep17:
    v_add_u32 v44, 117248, v16
    ds_read_b128 v[156:159], v44
    ds_read_b128 v[12:15], v44 offset:1024
    s_cmp_ge_u32 s39, 4
    s_cbranch_scc1 L_twave18
    s_setprio 2
    ds_read_b64 v[96:97], v26 offset:2112
    ds_read_b128 v[100:103], v27 offset:5120
    ds_read_b64 v[98:99], v26 offset:2120
    ds_read_b128 v[104:107], v27 offset:2560
    ds_read_b64 v[108:109], v26 offset:2048
    ds_read_b128 v[112:115], v27 offset:5040
    ds_read_b64 v[110:111], v26 offset:2056
    ds_read_b128 v[116:119], v27 offset:2480
    ds_read_b64 v[120:121], v26 offset:1984
    ds_read_b128 v[124:127], v27 offset:4960
    ds_read_b64 v[122:123], v26 offset:1992
    ds_read_b128 v[128:131], v27 offset:2400
    s_waitcnt lgkmcnt(8)
    v_mfma_f32_32x32x16_f16 v[80:95], v[96:99], v[100:103], 0
    ds_read_b64 v[132:133], v26 offset:1920
    ds_read_b128 v[136:139], v27 offset:4880
    v_mfma_f32_32x32x16_f16 v[64:79], v[96:99], v[104:107], 0
    ds_read_b64 v[134:135], v26 offset:1928
    ds_read_b128 v[140:143], v27 offset:2320
    s_waitcnt lgkmcnt(8)
    v_mfma_f32_32x32x16_f16 v[80:95], v[108:111], v[112:115], v[80:95]
    ds_read_b64 v[96:97], v26 offset:1856
    ds_read_b128 v[100:103], v27 offset:4800
    v_mfma_f32_32x32x16_f16 v[64:79], v[108:111], v[116:119], v[64:79]
    ds_read_b64 v[98:99], v26 offset:1864
    ds_read_b128 v[104:107], v27 offset:2240
    s_waitcnt lgkmcnt(8)
    v_mfma_f32_32x32x16_f16 v[80:95], v[120:123], v[124:127], v[80:95]
    ds_read_b64 v[108:109], v26 offset:1792
    ds_read_b128 v[112:115], v27 offset:4720
    v_mfma_f32_32x32x16_f16 v[64:79], v[120:123], v[128:131], v[64:79]
    ds_read_b64 v[110:111], v26 offset:1800
    ds_read_b128 v[116:119], v27 offset:2160
    s_waitcnt lgkmcnt(8)
    v_mfma_f32_32x32x16_f16 v[80:95], v[132:135], v[136:139], v[80:95]
    ds_read_b64 v[120:121], v26 offset:1728
    ds_read_b128 v[124:127], v27 offset:4640
    v_mfma_f32_32x32x16_f16 v[64:79], v[132:135], v[140:143], v[64:79]
    ds_read_b64 v[122:123], v26 offset:1736
    ds_read_b128 v[128:131], v27 offset:2080
    s_waitcnt lgkmcnt(8)
    v_mfma_f32_32x32x16_f16 v[80:95], v[96:99], v[100:103], v[80:95]
    ds_read_b64 v[132:133], v26 offset:1664
    ds_read_b128 v[136:139], v27 offset:4560
    v_mfma_f32_32x32x16_f16 v[64:79], v[96:99], v[104:107], v[64:79]
    ds_read_b64 v[134:135], v26 offset:1672
    ds_read_b128 v[140:143], v27 offset:2000
    s_waitcnt lgkmcnt(8)
    v_mfma_f32_32x32x16_f16 v[80:95], v[108:111], v[112:115], v[80:95]
    ds_read_b64 v[96:97], v26 offset:1600
    ds_read_b128 v[100:103], v27 offset:4480
    v_mfma_f32_32x32x16_f16 v[64:79], v[108:111], v[116:119], v[64:79]
    ds_read_b64 v[98:99], v26 offset:1608
    ds_read_b128 v[104:107], v27 offset:1920
    s_waitcnt lgkmcnt(8)
    v_mfma_f32_32x32x16_f16 v[80:95], v[120:123], v[124:127], v[80:95]
    ds_read_b64 v[108:109], v26 offset:1536
    ds_read_b128 v[112:115], v27 offset:4400
    v_mfma_f32_32x32x16_f16 v[64:79], v[120:123], v[128:131], v[64:79]
    ds_read_b64 v[110:111], v26 offset:1544
    ds_read_b128 v[116:119], v27 offset:1840
    s_waitcnt lgkmcnt(8)
    v_mfma_f32_32x32x16_f16 v[80:95], v[132:135], v[136:139], v[80:95]
    ds_read_b64 v[120:121], v26 offset:1472
    ds_read_b128 v[124:127], v27 offset:4320
    v_mfma_f32_32x32x16_f16 v[64:79], v[132:135], v[140:143], v[64:79]
    ds_read_b64 v[122:123], v26 offset:1480
    ds_read_b128 v[128:131], v27 offset:1760
    s_waitcnt lgkmcnt(8)
    v_mfma_f32_32x32x16_f16 v[80:95], v[96:99], v[100:103], v[80:95]
    ds_read_b64 v[132:133], v26 offset:1408
    ds_read_b128 v[136:139], v27 offset:4240
    v_mfma_f32_32x32x16_f16 v[64:79], v[96:99], v[104:107], v[64:79]
    ds_read_b64 v[134:135], v26 offset:1416
    ds_read_b128 v[140:143], v27 offset:1680
    s_waitcnt lgkmcnt(8)
    v_mfma_f32_32x32x16_f16 v[80:95], v[108:111], v[112:115], v[80:95]
    ds_read_b64 v[96:97], v26 offset:1344
    ds_read_b128 v[100:103], v27 offset:4160
    v_mfma_f32_32x32x16_f16 v[64:79], v[108:111], v[116:119], v[64:79]
    ds_read_b64 v[98:99], v26 offset:1352
    ds_read_b128 v[104:107], v27 offset:1600
    s_waitcnt lgkmcnt(8)
    v_mfma_f32_32x32x16_f16 v[80:95], v[120:123], v[124:127], v[80:95]
    ds_read_b64 v[108:109], v26 offset:1280
    ds_read_b128 v[112:115], v27 offset:4080
    v_mfma_f32_32x32x16_f16 v[64:79], v[120:123], v[128:131], v[64:79]
    ds_read_b64 v[110:111], v26 offset:1288
    ds_read_b128 v[116:119], v27 offset:1520
    s_waitcnt lgkmcnt(8)
    v_mfma_f32_32x32x16_f16 v[80:95], v[132:135], v[136:139], v[80:95]
    ds_read_b64 v[120:121], v26 offset:1216
    ds_read_b128 v[124:127], v27 offset:4000
    v_mfma_f32_32x32x16_f16 v[64:79], v[132:135], v[140:143], v[64:79]
    ds_read_b64 v[122:123], v26 offset:1224
    ds_read_b128 v[128:131], v27 offset:1440
    s_waitcnt lgkmcnt(8)
    v_mfma_f32_32x32x16_f16 v[80:95], v[96:99], v[100:103], v[80:95]
    ds_read_b64 v[132:133], v26 offset:1152
    ds_read_b128 v[136:139], v27 offset:3920
    v_mfma_f32_32x32x16_f16 v[64:79], v[96:99], v[104:107], v[64:79]
    ds_read_b64 v[134:135], v26 offset:1160
    ds_read_b128 v[140:143], v27 offset:1360
    s_waitcnt lgkmcnt(8)
    v_mfma_f32_32x32x16_f16 v[80:95], v[108:111], v[112:115], v[80:95]
    ds_read_b64 v[96:97], v26 offset:1088
    ds_read_b128 v[100:103], v27 offset:3840
    v_mfma_f32_32x32x16_f16 v[64:79], v[108:111], v[116:119], v[64:79]
    ds_read_b64 v[98:99], v26 offset:1096
    ds_read_b128 v[104:107], v27 offset:1280
    s_waitcnt lgkmcnt(8)
    v_mfma_f32_32x32x16_f16 v[80:95], v[120:123], v[124:127], v[80:95]
    ds_read_b64 v[108:109], v26 offset:1024
    ds_read_b128 v[112:115], v27 offset:3760
    v_mfma_f32_32x32x16_f16 v[64:79], v[120:123], v[128:131], v[64:79]
    ds_read_b64 v[110:111], v26 offset:1032
    ds_read_b128 v[116:119], v27 offset:1200
    s_waitcnt lgkmcnt(8)
    v_mfma_f32_32x32x16_f16 v[80:95], v[132:135], v[136:139], v[80:95]
    ds_read_b64 v[120:121], v26 offset:960
    ds_read_b128 v[124:127], v27 offset:3680
    v_mfma_f32_32x32x16_f16 v[64:79], v[132:135], v[140:143], v[64:79]
    ds_read_b64 v[122:123], v26 offset:968
    ds_read_b128 v[128:131], v27 offset:1120
    s_waitcnt lgkmcnt(8)
    v_mfma_f32_32x32x16_f16 v[80:95], v[96:99], v[100:103], v[80:95]
    ds_read_b64 v[132:133], v26 offset:896
    ds_read_b128 v[136:139], v27 offset:3600
    v_mfma_f32_32x32x16_f16 v[64:79], v[96:99], v[104:107], v[64:79]
    ds_read_b64 v[134:135], v26 offset:904
    ds_read_b128 v[140:143], v27 offset:1040
    s_waitcnt lgkmcnt(8)
    v_mfma_f32_32x32x16_f16 v[80:95], v[108:111], v[112:115], v[80:95]
    ds_read_b64 v[96:97], v26 offset:832
    ds_read_b128 v[100:103], v27 offset:3520
    v_mfma_f32_32x32x16_f16 v[64:79], v[108:111], v[116:119], v[64:79]
    ds_read_b64 v[98:99], v26 offset:840
    ds_read_b128 v[104:107], v27 offset:960
    s_waitcnt lgkmcnt(8)
    v_mfma_f32_32x32x16_f16 v[80:95], v[120:123], v[124:127], v[80:95]
    ds_read_b64 v[108:109], v26 offset:768
    ds_read_b128 v[112:115], v27 offset:3440
    v_mfma_f32_32x32x16_f16 v[64:79], v[120:123], v[128:131], v[64:79]
    ds_read_b64 v[110:111], v26 offset:776
    ds_read_b128 v[116:119], v27 offset:880
    s_waitcnt lgkmcnt(8)
    v_mfma_f32_32x32x16_f16 v[80:95], v[132:135], v[136:139], v[80:95]
    ds_read_b64 v[120:121], v26 offset:704
    ds_read_b128 v[124:127], v27 offset:3360
    v_mfma_f32_32x32x16_f16 v[64:79], v[132:135], v[140:143], v[64:79]
    ds_read_b64 v[122:123], v26 offset:712
    ds_read_b128 v[128:131], v27 offset:800
    s_waitcnt lgkmcnt(8)
    v_mfma_f32_32x32x16_f16 v[80:95], v[96:99], v[100:103], v[80:95]
    ds_read_b64 v[132:133], v26 offset:640
    ds_read_b128 v[136:139], v27 offset:3280
    v_mfma_f32_32x32x16_f16 v[64:79], v[96:99], v[104:107], v[64:79]
    ds_read_b64 v[134:135], v26 offset:648
    ds_read_b128 v[140:143], v27 offset:720
    s_waitcnt lgkmcnt(8)
    v_mfma_f32_32x32x16_f16 v[80:95], v[108:111], v[112:115], v[80:95]
    ds_read_b64 v[96:97], v26 offset:576
    ds_read_b128 v[100:103], v27 offset:3200
    v_mfma_f32_32x32x16_f16 v[64:79], v[108:111], v[116:119], v[64:79]
    ds_read_b64 v[98:99], v26 offset:584
    ds_read_b128 v[104:107], v27 offset:640
    s_waitcnt lgkmcnt(8)
    v_mfma_f32_32x32x16_f16 v[80:95], v[120:123], v[124:127], v[80:95]
    ds_read_b64 v[108:109], v26 offset:512
    ds_read_b128 v[112:115], v27 offset:3120
    v_mfma_f32_32x32x16_f16 v[64:79], v[120:123], v[128:131], v[64:79]
    ds_read_b64 v[110:111], v26 offset:520
    ds_read_b128 v[116:119], v27 offset:560
    s_waitcnt lgkmcnt(8)
    v_mfma_f32_32x32x16_f16 v[80:95], v[132:135], v[136:139], v[80:95]
    ds_read_b64 v[120:121], v26 offset:448
    ds_read_b128 v[124:127], v27 offset:3040
    v_mfma_f32_32x32x16_f16 v[64:79], v[132:135], v[140:143], v[64:79]
    ds_read_b64 v[122:123], v26 offset:456
    ds_read_b128 v[128:131], v27 offset:480
    s_waitcnt lgkmcnt(8)
    v_mfma_f32_32x32x16_f16 v[80:95], v[96:99], v[100:103], v[80:95]
    ds_read_b64 v[132:133], v26 offset:384
    ds_read_b128 v[136:139], v27 offset:2960
    v_mfma_f32_32x32x16_f16 v[64:79], v[96:99], v[104:107], v[64:79]
    ds_read_b64 v[134:135], v26 offset:392
    ds_read_b128 v[140:143], v27 offset:400
    s_waitcnt lgkmcnt(8)
    v_mfma_f32_32x32x16_f16 v[80:95], v[108:111], v[112:115], v[80:95]
    ds_read_b64 v[96:97], v26 offset:320
    ds_read_b128 v[100:103], v27 offset:2880
    v_mfma_f32_32x32x16_f16 v[64:79], v[108:111], v[116:119], v[64:79]
    ds_read_b64 v[98:99], v26 offset:328
    ds_read_b128 v[104:107], v27 offset:320
    s_waitcnt lgkmcnt(8)
    v_mfma_f32_32x32x16_f16 v[80:95], v[120:123], v[124:127], v[80:95]
    ds_read_b64 v[108:109], v26 offset:256
    ds_read_b128 v[112:115], v27 offset:2800
    v_mfma_f32_32x32x16_f16 v[64:79], v[120:123], v[128:131], v[64:79]
    ds_read_b64 v[110:111], v26 offset:264
    ds_read_b128 v[116:119], v27 offset:240
    s_waitcnt lgkmcnt(8)
    v_mfma_f32_32x32x16_f16 v[80:95], v[132:135], v[136:139], v[80:95]
    ds_read_b64 v[120:121], v26 offset:192
    ds_read_b128 v[124:127], v27 offset:2720
    v_mfma_f32_32x32x16_f16 v[64:79], v[132:135], v[140:143], v[64:79]
    ds_read_b64 v[122:123], v26 offset:200
    ds_read_b128 v[128:131], v27 offset:160
    ds_read_b64 v[160:161], v162
    s_waitcnt lgkmcnt(9)
    v_mfma_f32_32x32x16_f16 v[80:95], v[96:99], v[100:103], v[80:95]
    ds_read_b64 v[132:133], v26 offset:128
    ds_read_b128 v[136:139], v27 offset:2640
    v_mfma_f32_32x32x16_f16 v[64:79], v[96:99], v[104:107], v[64:79]
    ds_read_b64 v[134:135], v26 offset:136
    ds_read_b128 v[140:143], v27 offset:80
    s_waitcnt lgkmcnt(9)
    v_mfma_f32_32x32x16_f16 v[80:95], v[108:111], v[112:115], v[80:95]
    ds_read_b64 v[96:97], v26 offset:64
    ds_read_b128 v[100:103], v27 offset:2560
    v_mfma_f32_32x32x16_f16 v[64:79], v[108:111], v[116:119], v[64:79]
    ds_read_b64 v[98:99], v26 offset:72
    s_waitcnt lgkmcnt(7)
    v_mfma_f32_32x32x16_f16 v[80:95], v[120:123], v[124:127], v[80:95]
    ds_read_b64 v[108:109], v26 offset:0
    ds_read_b128 v[112:115], v27 offset:2480
    v_mfma_f32_32x32x16_f16 v[64:79], v[120:123], v[128:131], v[64:79]
    ds_read_b64 v[110:111], v26 offset:8
    s_waitcnt lgkmcnt(6)
L_xsp20:
    v_and_b32 v163, v160, v161
    s_nop 0
    v_readfirstlane_b32 s48, v163
    s_nop 0
    s_cmp_eq_u32 s48, 1
    s_cbranch_scc1 L_xgo21
    ds_read_b64 v[160:161], v162
    s_waitcnt lgkmcnt(0)
    s_nop 1
    s_branch L_xsp20
L_xgo21:
    v_mfma_f32_32x32x16_f16 v[80:95], v[132:135], v[136:139], v[80:95]
    ds_read_b64_tr_b16 v[120:121], v164 offset:48
    ds_read_b64_tr_b16 v[122:123], v164 offset:304
    v_mfma_f32_32x32x16_f16 v[64:79], v[132:135], v[140:143], v[64:79]
    ds_read_b64 v[124:125], v26 offset:2360
    ds_read_b64 v[126:127], v26 offset:2368
    s_waitcnt lgkmcnt(7)
    v_mfma_f32_32x32x16_f16 v[80:95], v[96:99], v[100:103], v[80:95]
    ds_read_b64_tr_b16 v[132:133], v164 offset:2144
    ds_read_b64_tr_b16 v[134:135], v164 offset:2400
    ds_read_b64 v[136:137], v26 offset:2552
    ds_read_b64 v[138:139], v26 offset:2560
    s_waitcnt lgkmcnt(8)
    v_mfma_f32_32x32x16_f16 v[80:95], v[108:111], v[112:115], v[80:95]
    ds_read_b64_tr_b16 v[96:97], v164 offset:16
    ds_read_b64_tr_b16 v[98:99], v164 offset:272
    ds_read_b64 v[100:101], v26 offset:2744
    ds_read_b64 v[102:103], v26 offset:2752
    s_waitcnt lgkmcnt(8)
    v_mfma_f32_32x32x16_f16 v[80:95], v[120:123], v[124:127], v[80:95]
    ds_read_b64_tr_b16 v[108:109], v164 offset:2112
    ds_read_b64_tr_b16 v[110:111], v164 offset:2368
    ds_read_b64 v[112:113], v26 offset:2936
    ds_read_b64 v[114:115], v26 offset:2944
    s_waitcnt lgkmcnt(8)
    v_mfma_f32_32x32x16_f16 v[80:95], v[132:135], v[136:139], v[80:95]
    ds_write_b128 v28, v[64:67] offset:0
    ds_write_b128 v28, v[68:71] offset:32
    ds_write_b128 v28, v[72:75] offset:64
    ds_write_b128 v28, v[76:79] offset:96
    s_waitcnt lgkmcnt(8)
    v_mfma_f32_32x32x16_f16 v[80:95], v[96:99], v[100:103], v[80:95]
    s_waitcnt lgkmcnt(4)
    v_mfma_f32_32x32x16_f16 v[80:95], v[108:111], v[112:115], v[80:95]
    s_nop 11
    ds_write_b128 v28, v[80:83] offset:4608
    ds_write_b128 v28, v[84:87] offset:4640
    ds_write_b128 v28, v[88:91] offset:4672
    ds_write_b128 v28, v[92:95] offset:4704
    s_setprio 0
    s_branch L_convdone19
L_twave18:
    s_bfe_u32 s48, s39, 0x10001
    s_and_b32 s49, s39, 1
    s_lshl_b32 s50, s48, 1
    s_add_u32 s50, s50, s49
    s_mul_i32 s50, s50, 2112
    s_add_u32 s50, s50, 99584
    s_mul_i32 s51, s48, 7680
    s_add_u32 s51, s51, 86704
    v_add_u32 v40, 3, v1
    v_subrev_u32 v44, 1, v40
    v_lshrrev_b32 v45, 2, v44
    v_mul_u32_u24 v45, 80, v45
    v_and_b32 v44, 3, v44
    v_lshlrev_b32 v44, 4, v44
    v_add3_u32 v41, v45, v44, s51
    v_add_u32 v44, 0, v40
    v_lshrrev_b32 v45, 2, v44
    v_mul_u32_u24 v45, 80, v45
    v_and_b32 v44, 3, v44
    v_lshlrev_b32 v44, 4, v44
    v_add3_u32 v42, v45, v44, s51
    v_add_u32 v44, 1, v40
    v_lshrrev_b32 v45, 2, v44
    v_mul_u32_u24 v45, 80, v45
    v_and_b32 v44, 3, v44
    v_lshlrev_b32 v44, 4, v44
    v_add3_u32 v43, v45, v44, s51
    ds_read_b64 v[46:47], v41 offset:8
    ds_read_b128 v[48:51], v42
    ds_read_b64 v[52:53], v43
    s_waitcnt lgkmcnt(0)
    v_cvt_f32_f16 v96, v46
    v_cvt_f32_f16_sdwa v97, v46 dst_sel:DWORD dst_unused:UNUSED_PAD src0_sel:WORD_1
    v_cvt_f32_f16 v98, v47
    v_cvt_f32_f16_sdwa v99, v47 dst_sel:DWORD dst_unused:UNUSED_PAD src0_sel:WORD_1
    v_cvt_f32_f16 v100, v48
    v_cvt_f32_f16_sdwa v101, v48 dst_sel:DWORD dst_unused:UNUSED_PAD src0_sel:WORD_1
    v_cvt_f32_f16 v102, v49
    v_cvt_f32_f16_sdwa v103, v49 dst_sel:DWORD dst_unused:UNUSED_PAD src0_sel:WORD_1
    v_cvt_f32_f16 v104, v50
    v_cvt_f32_f16_sdwa v105, v50 dst_sel:DWORD dst_unused:UNUSED_PAD src0_sel:WORD_1
    v_cvt_f32_f16 v106, v51
    v_cvt_f32_f16_sdwa v107, v51 dst_sel:DWORD dst_unused:UNUSED_PAD src0_sel:WORD_1
    v_cvt_f32_f16 v108, v52
    v_cvt_f32_f16_sdwa v109, v52 dst_sel:DWORD dst_unused:UNUSED_PAD src0_sel:WORD_1
    v_cvt_f32_f16 v110, v53
    v_cvt_f32_f16_sdwa v111, v53 dst_sel:DWORD dst_unused:UNUSED_PAD src0_sel:WORD_1
    s_cmp_eq_u32 s49, 0
    s_cbranch_scc1 L_o722
    v_add_f32 v120, v96, v97
    v_add_f32 v120, v120, v98
    v_add_f32 v120, v120, v99
    v_add_f32 v120, v120, v100
    v_add_f32 v120, v120, v101
    v_add_f32 v120, v120, v102
    v_add_f32 v120, v120, v103
    v_add_f32 v120, v120, v104
    v_sub_f32 v121, v105, v96
    v_add_f32 v121, v121, v120
    v_sub_f32 v122, v106, v97
    v_add_f32 v122, v122, v121
    v_sub_f32 v123, v107, v98
    v_add_f32 v123, v123, v122
    v_sub_f32 v124, v108, v99
    v_add_f32 v124, v124, v123
    v_sub_f32 v125, v109, v100
    v_add_f32 v125, v125, v124
    v_sub_f32 v126, v110, v101
    v_add_f32 v126, v126, v125
    v_sub_f32 v127, v111, v102
    v_add_f32 v127, v127, v126
    s_branch L_xj23
L_o722:
    v_add_f32 v120, v97, v98
    v_add_f32 v120, v120, v99
    v_add_f32 v120, v120, v100
    v_add_f32 v120, v120, v101
    v_add_f32 v120, v120, v102
    v_add_f32 v120, v120, v103
    v_sub_f32 v121, v104, v97
    v_add_f32 v121, v121, v120
    v_sub_f32 v122, v105, v98
    v_add_f32 v122, v122, v121
    v_sub_f32 v123, v106, v99
    v_add_f32 v123, v123, v122
    v_sub_f32 v124, v107, v100
    v_add_f32 v124, v124, v123
    v_sub_f32 v125, v108, v101
    v_add_f32 v125, v125, v124
    v_sub_f32 v126, v109, v102
    v_add_f32 v126, v126, v125
    v_sub_f32 v127, v110, v103
    v_add_f32 v127, v127, v126
L_xj23:
    v_cvt_pk_f16_f32 v48, v120, v121
    v_cvt_pk_f16_f32 v49, v122, v123
    v_cvt_pk_f16_f32 v50, v124, v125
    v_cvt_pk_f16_f32 v51, v126, v127
    v_add_u32 v44, s50, v16
    ds_write_b128 v44, v[48:51] offset:48
    v_add_u32 v40, 67, v1
    v_subrev_u32 v44, 1, v40
    v_lshrrev_b32 v45, 2, v44
    v_mul_u32_u24 v45, 80, v45
    v_and_b32 v44, 3, v44
    v_lshlrev_b32 v44, 4, v44
    v_add3_u32 v41, v45, v44, s51
    v_add_u32 v44, 0, v40
    v_lshrrev_b32 v45, 2, v44
    v_mul_u32_u24 v45, 80, v45
    v_and_b32 v44, 3, v44
    v_lshlrev_b32 v44, 4, v44
    v_add3_u32 v42, v45, v44, s51
    v_add_u32 v44, 1, v40
    v_lshrrev_b32 v45, 2, v44
    v_mul_u32_u24 v45, 80, v45
    v_and_b32 v44, 3, v44
    v_lshlrev_b32 v44, 4, v44
    v_add3_u32 v43, v45, v44, s51
    ds_read_b64 v[46:47], v41 offset:8
    ds_read_b128 v[48:51], v42
    ds_read_b64 v[52:53], v43
    s_waitcnt lgkmcnt(0)
    v_cvt_f32_f16 v96, v46
    v_cvt_f32_f16_sdwa v97, v46 dst_sel:DWORD dst_unused:UNUSED_PAD src0_sel:WORD_1
    v_cvt_f32_f16 v98, v47
    v_cvt_f32_f16_sdwa v99, v47 dst_sel:DWORD dst_unused:UNUSED_PAD src0_sel:WORD_1
    v_cvt_f32_f16 v100, v48
    v_cvt_f32_f16_sdwa v101, v48 dst_sel:DWORD dst_unused:UNUSED_PAD src0_sel:WORD_1
    v_cvt_f32_f16 v102, v49
    v_cvt_f32_f16_sdwa v103, v49 dst_sel:DWORD dst_unused:UNUSED_PAD src0_sel:WORD_1
    v_cvt_f32_f16 v104, v50
    v_cvt_f32_f16_sdwa v105, v50 dst_sel:DWORD dst_unused:UNUSED_PAD src0_sel:WORD_1
    v_cvt_f32_f16 v106, v51
    v_cvt_f32_f16_sdwa v107, v51 dst_sel:DWORD dst_unused:UNUSED_PAD src0_sel:WORD_1
    v_cvt_f32_f16 v108, v52
    v_cvt_f32_f16_sdwa v109, v52 dst_sel:DWORD dst_unused:UNUSED_PAD src0_sel:WORD_1
    v_cvt_f32_f16 v110, v53
    v_cvt_f32_f16_sdwa v111, v53 dst_sel:DWORD dst_unused:UNUSED_PAD src0_sel:WORD_1
    s_cmp_eq_u32 s49, 0
    s_cbranch_scc1 L_o724
    v_add_f32 v120, v96, v97
    v_add_f32 v120, v120, v98
    v_add_f32 v120, v120, v99
    v_add_f32 v120, v120, v100
    v_add_f32 v120, v120, v101
    v_add_f32 v120, v120, v102
    v_add_f32 v120, v120, v103
    v_add_f32 v120, v120, v104
    v_sub_f32 v121, v105, v96
    v_add_f32 v121, v121, v120
    v_sub_f32 v122, v106, v97
    v_add_f32 v122, v122, v121
    v_sub_f32 v123, v107, v98
    v_add_f32 v123, v123, v122
    v_sub_f32 v124, v108, v99
    v_add_f32 v124, v124, v123
    v_sub_f32 v125, v109, v100
    v_add_f32 v125, v125, v124
    v_sub_f32 v126, v110, v101
    v_add_f32 v126, v126, v125
    v_sub_f32 v127, v111, v102
    v_add_f32 v127, v127, v126
    s_branch L_xj25
L_o724:
    v_add_f32 v120, v97, v98
    v_add_f32 v120, v120, v99
    v_add_f32 v120, v120, v100
    v_add_f32 v120, v120, v101
    v_add_f32 v120, v120, v102
    v_add_f32 v120, v120, v103
    v_sub_f32 v121, v104, v97
    v_add_f32 v121, v121, v120
    v_sub_f32 v122, v105, v98
    v_add_f32 v122, v122, v121
    v_sub_f32 v123, v106, v99
    v_add_f32 v123, v123, v122
    v_sub_f32 v124, v107, v100
    v_add_f32 v124, v124, v123
    v_sub_f32 v125, v108, v101
    v_add_f32 v125, v125, v124
    v_sub_f32 v126, v109, v102
    v_add_f32 v126, v126, v125
    v_sub_f32 v127, v110, v103
    v_add_f32 v127, v127, v126
L_xj25:
    v_cvt_pk_f16_f32 v48, v120, v121
    v_cvt_pk_f16_f32 v49, v122, v123
    v_cvt_pk_f16_f32 v50, v124, v125
    v_cvt_pk_f16_f32 v51, v126, v127
    v_add_u32 v44, s50, v16
    ds_write_b128 v44, v[48:51] offset:1072
    s_and_b32 s48, s39, 3
    s_lshl_b32 s48, s48, 2
    s_add_u32 s48, s48, 163328
    v_mov_b32 v44, s48
    v_mov_b32 v45, 1
    s_waitcnt lgkmcnt(0)
    s_mov_b64 exec, 1
    ds_write_b32 v44, v45
    s_mov_b64 exec, -1
L_convdone19:
    v_mov_b32 v46, 0x3b000000
    v_mov_b32 v44, 0xfff8fff8
    s_waitcnt lgkmcnt(0)
    s_barrier
    ds_read_b128 v[64:67], v29
    ds_read_b128 v[68:71], v29 offset:16
    ds_read_b128 v[72:75], v29 offset:18432
    ds_read_b128 v[76:79], v29 offset:18448
    s_waitcnt lgkmcnt(0)
    v_pk_add_f32 v[64:65], v[64:65], v[72:73]
    v_pk_add_f32 v[66:67], v[66:67], v[74:75]
    v_pk_add_f32 v[68:69], v[68:69], v[76:77]
    v_pk_add_f32 v[70:71], v[70:71], v[78:79]
    v_cvt_pk_bf16_f32 v72, v64, v65
    v_cvt_pk_bf16_f32 v73, v66, v67
    v_cvt_pk_bf16_f32 v74, v68, v69
    v_cvt_pk_bf16_f32 v75, v70, v71
    v_lshlrev_b32 v64, 16, v72
    v_and_b32 v65, 0xffff0000, v72
    v_lshlrev_b32 v66, 16, v73
    v_and_b32 v67, 0xffff0000, v73
    v_lshlrev_b32 v68, 16, v74
    v_and_b32 v69, 0xffff0000, v74
    v_lshlrev_b32 v70, 16, v75
    v_and_b32 v71, 0xffff0000, v75
    v_pk_mul_f32 v[64:65], v[64:65], v[46:47] op_sel_hi:[1,0]
    v_pk_mul_f32 v[66:67], v[66:67], v[46:47] op_sel_hi:[1,0]
    v_pk_mul_f32 v[68:69], v[68:69], v[46:47] op_sel_hi:[1,0]
    v_pk_mul_f32 v[70:71], v[70:71], v[46:47] op_sel_hi:[1,0]
    v_cvt_pk_f16_f32 v72, v64, v65
    v_cvt_pk_f16_f32 v73, v66, v67
    v_cvt_pk_f16_f32 v74, v68, v69
    v_cvt_pk_f16_f32 v75, v70, v71
    v_and_or_b32 v72, v72, v44, s40
    v_and_or_b32 v73, v73, v44, s41
    v_and_or_b32 v74, v74, v44, s42
    v_and_or_b32 v75, v75, v44, s43
    global_store_dwordx4 v17, v[72:75], s[58:59] sc1
    v_lshlrev_b32 v40, 16, v4
    v_and_b32 v41, 0xffff0000, v4
    v_lshlrev_b32 v42, 16, v5
    v_and_b32 v43, 0xffff0000, v5
    v_lshlrev_b32 v44, 16, v6
    v_and_b32 v45, 0xffff0000, v6
    v_lshlrev_b32 v46, 16, v7
    v_and_b32 v47, 0xffff0000, v7
    v_lshlrev_b32 v52, 16, v8
    v_and_b32 v53, 0xffff0000, v8
    v_lshlrev_b32 v54, 16, v9
    v_and_b32 v55, 0xffff0000, v9
    v_lshlrev_b32 v56, 16, v10
    v_and_b32 v57, 0xffff0000, v10
    v_lshlrev_b32 v58, 16, v11
    v_and_b32 v59, 0xffff0000, v11
    s_lshl_b32 s49, s69, 10
    v_add_u32 v69, s49, v16
    v_lshlrev_b32 v80, 16, v156
    v_and_b32 v81, 0xffff0000, v156
    v_lshlrev_b32 v82, 16, v157
    v_and_b32 v83, 0xffff0000, v157
    v_lshlrev_b32 v84, 16, v158
    v_and_b32 v85, 0xffff0000, v158
    v_lshlrev_b32 v86, 16, v159
    v_and_b32 v87, 0xffff0000, v159
    v_pk_mul_f32 v[52:53], v[52:53], v[80:81]
    v_pk_mul_f32 v[54:55], v[54:55], v[82:83]
    v_pk_mul_f32 v[56:57], v[56:57], v[84:85]
    v_pk_mul_f32 v[58:59], v[58:59], v[86:87]
    v_cvt_pk_bf16_f32 v76, v52, v53
    v_cvt_pk_bf16_f32 v77, v54, v55
    v_cvt_pk_bf16_f32 v78, v56, v57
    v_cvt_pk_bf16_f32 v79, v58, v59
    v_lshlrev_b32 v52, 16, v76
    v_and_b32 v53, 0xffff0000, v76
    v_lshlrev_b32 v54, 16, v77
    v_and_b32 v55, 0xffff0000, v77
    v_lshlrev_b32 v56, 16, v78
    v_and_b32 v57, 0xffff0000, v78
    v_lshlrev_b32 v58, 16, v79
    v_and_b32 v59, 0xffff0000, v79
    s_waitcnt vmcnt(0)
    v_lshlrev_b32 v70, 3, v0
    v_add_u32 v70, 4366336, v70
    v_mov_b32 v71, 0x00070007
    v_mov_b32 v68, 0xfff8fff8
    v_lshlrev_b32 v66, 2, v0
    v_add_u32 v66, 59136, v66
    s_mov_b32 s55, 0
    global_load_dwordx4 v[72:75], v2, s[58:59] sc1
    global_load_dwordx2 v[76:77], v70, s[36:37] sc1
L_h2p26:
    s_waitcnt vmcnt(0)
    v_xor_b32 v60, s40, v72
    v_xor_b32 v61, s41, v73
    v_xor_b32 v62, s42, v74
    v_xor_b32 v63, s43, v75
    v_xor_b32 v64, s44, v77
    v_and_or_b32 v64, v60, v71, v64
    v_and_or_b32 v64, v61, v71, v64
    v_and_or_b32 v64, v62, v71, v64
    v_and_or_b32 v64, v63, v71, v64
    v_cmp_ne_u32 vcc, 0, v64
    s_cbranch_vccz L_h2ok27
    s_add_u32 s55, s55, 1
    s_cmp_lt_u32 s55, 0x20000
    s_cbranch_scc0 L_h2ok27
    s_and_b64 exec, exec, vcc
    s_sleep 4
    global_load_dwordx4 v[72:75], v2, s[58:59] sc1
    global_load_dwordx2 v[76:77], v70, s[36:37] sc1
    s_branch L_h2p26
L_h2ok27:
    s_mov_b64 exec, -1
    v_and_b32 v72, v72, v68
    v_and_b32 v73, v73, v68
    v_and_b32 v74, v74, v68
    v_and_b32 v75, v75, v68
    ds_write_b32 v66, v76
    ds_write_b16 v38, v72 offset:0
    ds_write_b16_d16_hi v38, v72 offset:1024
    ds_write_b16 v38, v73 offset:2048
    ds_write_b16_d16_hi v38, v73 offset:3072
    ds_write_b16 v38, v74 offset:4096
    ds_write_b16_d16_hi v38, v74 offset:5120
    ds_write_b16 v38, v75 offset:6144
    ds_write_b16_d16_hi v38, v75 offset:7168
    s_waitcnt lgkmcnt(0)
    s_barrier
    ds_read_b128 v[72:75], v39
    v_lshlrev_b32 v68, 5, v1
    v_add_u32 v68, 59136, v68
    ds_read_b128 v[60:63], v68
    ds_read_b128 v[64:67], v68 offset:16
    v_add_u32 v68, 108032, v3
    ds_write_b128 v68, v[32:35]
    v_mov_b32 v68, 163456
    v_add_u32 v68, v68, v16
    s_mov_b64 exec, 0x7f
    ds_write_b128 v68, v[32:35]
    s_mov_b64 exec, -1
    s_waitcnt lgkmcnt(2)
    v_cvt_f32_f16 v80, v72
    v_cvt_f32_f16_sdwa v81, v72 dst_sel:DWORD dst_unused:UNUSED_PAD src0_sel:WORD_1
    v_cvt_f32_f16 v82, v73
    v_cvt_f32_f16_sdwa v83, v73 dst_sel:DWORD dst_unused:UNUSED_PAD src0_sel:WORD_1
    v_cvt_f32_f16 v84, v74
    v_cvt_f32_f16_sdwa v85, v74 dst_sel:DWORD dst_unused:UNUSED_PAD src0_sel:WORD_1
    v_cvt_f32_f16 v86, v75
    v_cvt_f32_f16_sdwa v87, v75 dst_sel:DWORD dst_unused:UNUSED_PAD src0_sel:WORD_1
    v_pk_mul_f32 v[80:81], v[80:81], v[60:61]
    v_pk_mul_f32 v[82:83], v[82:83], v[62:63]
    v_pk_mul_f32 v[84:85], v[84:85], v[64:65]
    v_pk_mul_f32 v[86:87], v[86:87], v[66:67]
    v_pk_add_f32 v[80:81], v[80:81], v[52:53]
    v_pk_add_f32 v[82:83], v[82:83], v[54:55]
    v_pk_add_f32 v[84:85], v[84:85], v[56:57]
    v_pk_add_f32 v[86:87], v[86:87], v[58:59]
    v_cvt_pk_bf16_f32 v76, v80, v81
    v_cvt_pk_bf16_f32 v77, v82, v83
    v_cvt_pk_bf16_f32 v78, v84, v85
    v_cvt_pk_bf16_f32 v79, v86, v87
    v_lshlrev_b32 v80, 16, v76
    v_and_b32 v81, 0xffff0000, v76
    v_lshlrev_b32 v82, 16, v77
    v_and_b32 v83, 0xffff0000, v77
    v_lshlrev_b32 v84, 16, v78
    v_and_b32 v85, 0xffff0000, v78
    v_lshlrev_b32 v86, 16, v79
    v_and_b32 v87, 0xffff0000, v79
    v_pk_add_f32 v[80:81], v[80:81], v[40:41]
    v_pk_add_f32 v[82:83], v[82:83], v[42:43]
    v_pk_add_f32 v[84:85], v[84:85], v[44:45]
    v_pk_add_f32 v[86:87], v[86:87], v[46:47]
    v_cvt_pk_bf16_f32 v88, v80, v81
    v_cvt_pk_bf16_f32 v89, v82, v83
    v_cvt_pk_bf16_f32 v90, v84, v85
    v_cvt_pk_bf16_f32 v91, v86, v87
    global_store_dwordx4 v69, v[88:91], s[66:67] sc1
    v_lshlrev_b32 v40, 16, v88
    v_and_b32 v41, 0xffff0000, v88
    v_lshlrev_b32 v42, 16, v89
    v_and_b32 v43, 0xffff0000, v89
    v_lshlrev_b32 v44, 16, v90
    v_and_b32 v45, 0xffff0000, v90
    v_lshlrev_b32 v46, 16, v91
    v_and_b32 v47, 0xffff0000, v91
    v_readfirstlane_b32 s48, v40
    s_nop 1
    v_subrev_f32 v52, s48, v40
    v_subrev_f32 v53, s48, v41
    v_subrev_f32 v54, s48, v42
    v_subrev_f32 v55, s48, v43
    v_subrev_f32 v56, s48, v44
    v_subrev_f32 v57, s48, v45
    v_subrev_f32 v58, s48, v46
    v_subrev_f32 v59, s48, v47
    v_add_f32 v60, v52, v53
    v_mul_f32 v61, v52, v52
    v_fmac_f32 v61, v53, v53
    v_add_f32 v60, v60, v54
    v_fmac_f32 v61, v54, v54
    v_add_f32 v60, v60, v55
    v_fmac_f32 v61, v55, v55
    v_add_f32 v60, v60, v56
    v_fmac_f32 v61, v56, v56
    v_add_f32 v60, v60, v57
    v_fmac_f32 v61, v57, v57
    v_add_f32 v60, v60, v58
    v_fmac_f32 v61, v58, v58
    v_add_f32 v60, v60, v59
    v_fmac_f32 v61, v59, v59
    s_nop 0
    v_add_f32_dpp v60, v60, v60 row_ror:8 row_mask:0xf bank_mask:0xf
    v_add_f32_dpp v61, v61, v61 row_ror:8 row_mask:0xf bank_mask:0xf
    s_nop 0
    v_add_f32_dpp v60, v60, v60 row_ror:4 row_mask:0xf bank_mask:0xf
    v_add_f32_dpp v61, v61, v61 row_ror:4 row_mask:0xf bank_mask:0xf
    s_nop 0
    v_add_f32_dpp v60, v60, v60 row_ror:2 row_mask:0xf bank_mask:0xf
    v_add_f32_dpp v61, v61, v61 row_ror:2 row_mask:0xf bank_mask:0xf
    s_nop 0
    v_add_f32_dpp v60, v60, v60 row_ror:1 row_mask:0xf bank_mask:0xf
    v_add_f32_dpp v61, v61, v61 row_ror:1 row_mask:0xf bank_mask:0xf
    v_mov_b32 v62, v60
    v_mov_b32 v63, v61
    s_nop 0
    v_permlane16_swap_b32 v60, v62
    v_permlane16_swap_b32 v61, v63
    v_add_f32 v60, v60, v62
    v_add_f32 v61, v61, v63
    v_mov_b32 v62, v60
    v_mov_b32 v63, v61
    s_nop 0
    v_permlane32_swap_b32 v60, v62
    v_permlane32_swap_b32 v61, v63
    v_add_f32 v60, v60, v62
    v_add_f32 v61, v61, v63
    v_mul_f32 v60, 0x3b000000, v60
    v_mul_f32 v61, 0x3b000000, v61
    v_add_f32 v62, s48, v60
    v_fma_f32 v61, -v60, v60, v61
    v_max_f32 v61, 0, v61
    v_cvt_pk_bf16_f32 v62, v62, v61
    v_and_b32 v61, 0xffff0000, v62
    v_add_f32 v61, 0x3727c5ac, v61
    v_lshlrev_b32 v48, 16, v62
    v_cvt_pk_bf16_f32 v61, v61, v61
    v_lshlrev_b32 v61, 16, v61
    v_sqrt_f32 v61, v61
    s_nop 0
    v_cvt_pk_bf16_f32 v61, v61, v61
    v_lshlrev_b32 v61, 16, v61
    v_rcp_f32 v50, v61
    v_pk_add_f32 v[52:53], v[40:41], v[48:49] op_sel_hi:[1,0] neg_lo:[0,1] neg_hi:[0,1]
    v_pk_add_f32 v[54:55], v[42:43], v[48:49] op_sel_hi:[1,0] neg_lo:[0,1] neg_hi:[0,1]
    v_pk_add_f32 v[56:57], v[44:45], v[48:49] op_sel_hi:[1,0] neg_lo:[0,1] neg_hi:[0,1]
    v_pk_add_f32 v[58:59], v[46:47], v[48:49] op_sel_hi:[1,0] neg_lo:[0,1] neg_hi:[0,1]
    v_cvt_pk_bf16_f32 v60, v52, v53
    v_cvt_pk_bf16_f32 v61, v54, v55
    v_cvt_pk_bf16_f32 v62, v56, v57
    v_cvt_pk_bf16_f32 v63, v58, v59
    v_lshlrev_b32 v52, 16, v60
    v_and_b32 v53, 0xffff0000, v60
    v_lshlrev_b32 v54, 16, v61
    v_and_b32 v55, 0xffff0000, v61
    v_lshlrev_b32 v56, 16, v62
    v_and_b32 v57, 0xffff0000, v62
    v_lshlrev_b32 v58, 16, v63
    v_and_b32 v59, 0xffff0000, v63
    v_pk_mul_f32 v[52:53], v[52:53], v[50:51] op_sel_hi:[1,0]
    v_pk_mul_f32 v[54:55], v[54:55], v[50:51] op_sel_hi:[1,0]
    v_pk_mul_f32 v[56:57], v[56:57], v[50:51] op_sel_hi:[1,0]
    v_pk_mul_f32 v[58:59], v[58:59], v[50:51] op_sel_hi:[1,0]
    v_cvt_pk_bf16_f32 v92, v52, v53
    v_cvt_pk_bf16_f32 v93, v54, v55
    v_cvt_pk_bf16_f32 v94, v56, v57
    v_cvt_pk_bf16_f32 v95, v58, v59
    global_store_dwordx4 v69, v[92:95], s[64:65] sc1
    v_mov_b32 v64, 0
    v_dot2_f32_bf16 v64, v92, v12, v64
    v_dot2_f32_bf16 v64, v93, v13, v64
    v_dot2_f32_bf16 v64, v94, v14, v64
    v_dot2_f32_bf16 v64, v95, v15, v64
    v_lshlrev_b32 v80, 16, v92
    v_and_b32 v81, 0xffff0000, v92
    v_lshlrev_b32 v82, 16, v93
    v_and_b32 v83, 0xffff0000, v93
    v_lshlrev_b32 v84, 16, v94
    v_and_b32 v85, 0xffff0000, v94
    v_lshlrev_b32 v86, 16, v95
    v_and_b32 v87, 0xffff0000, v95
    v_pk_add_f32 v[80:81], v[80:81], v[40:41]
    v_pk_add_f32 v[82:83], v[82:83], v[42:43]
    v_pk_add_f32 v[84:85], v[84:85], v[44:45]
    v_pk_add_f32 v[86:87], v[86:87], v[46:47]
    v_cvt_pk_bf16_f32 v96, v80, v81
    v_cvt_pk_bf16_f32 v97, v82, v83
    v_cvt_pk_bf16_f32 v98, v84, v85
    v_cvt_pk_bf16_f32 v99, v86, v87
    global_store_dwordx4 v69, v[96:99], s[32:33] sc1
    v_add_f32_dpp v64, v64, v64 row_ror:8 row_mask:0xf bank_mask:0xf
    s_nop 1
    v_add_f32_dpp v64, v64, v64 row_ror:4 row_mask:0xf bank_mask:0xf
    s_nop 1
    v_add_f32_dpp v64, v64, v64 row_ror:2 row_mask:0xf bank_mask:0xf
    s_nop 1
    v_add_f32_dpp v64, v64, v64 row_ror:1 row_mask:0xf bank_mask:0xf
    v_mov_b32 v65, v64
    s_nop 1
    v_permlane16_swap_b32 v64, v65
    v_add_f32 v64, v64, v65
    v_mov_b32 v65, v64
    s_nop 1
    v_permlane32_swap_b32 v64, v65
    v_add_f32 v64, v64, v65
    v_cvt_pk_bf16_f32 v64, v64, v64
    v_lshlrev_b32 v64, 16, v64
    v_ashrrev_i32 v65, 31, v64
    v_or_b32 v65, 0x80000000, v65
    v_xor_b32 v64, v64, v65
    v_and_b32 v64, 0xffff0000, v64
    s_sub_u32 s49, 34815, s69
    v_or_b32 v64, s49, v64
    s_lshl_b32 s49, s39, 2
    s_add_u32 s49, s49, 163392
    v_mov_b32 v65, s49
    ds_write_b32 v65, v64
    s_waitcnt vmcnt(0) lgkmcnt(0)
    s_barrier
    s_cmp_eq_u32 s39, 0
    s_cbranch_scc0 L_nokey28
    v_add_u32 v53, 163392, v16
    s_lshl_b32 s48, s38, 5
    v_add_u32 v54, s48, v16
    s_mov_b64 exec, 3
    ds_read_b128 v[56:59], v53
    s_waitcnt lgkmcnt(0)
    global_store_dwordx4 v54, v[56:59], s[60:61] sc1
    s_mov_b64 exec, -1
L_nokey28:
    s_cmp_ge_u32 s2, 176
    s_cbranch_scc1 L_FIN
    v_lshrrev_b32 v42, 3, v0
    v_lshlrev_b32 v42, 2, v42
    v_add_u32 v42, 108032, v42
    v_and_b32 v43, 7, v0
    v_lshlrev_b32 v43, 4, v43
    v_add_u32 v43, 108032, v43
    s_lshl_b32 s48, s39, 2
    s_add_u32 s48, s48, 163456
    v_mov_b32 v44, s48
    v_mov_b32 v45, 163456
    v_mov_b32 v46, 163520
    s_waitcnt vmcnt(0) lgkmcnt(0)
    s_barrier
    s_mov_b32 s55, 0
    global_load_dwordx4 v[72:75], v3, s[60:61] sc1
L_kp29:
    s_waitcnt vmcnt(0)
    v_min3_u32 v68, v72, v73, v74
    v_min_u32 v68, v68, v75
    v_cmp_eq_u32 vcc, 0, v68
    s_cbranch_vccz L_kok30
    s_add_u32 s55, s55, 1
    s_cmp_lt_u32 s55, 0x20000
    s_cbranch_scc0 L_kok30
    s_and_b64 exec, exec, vcc
    s_sleep 4
    global_load_dwordx4 v[72:75], v3, s[60:61] sc1
    s_branch L_kp29
L_kok30:
    s_mov_b64 exec, -1
    v_max3_u32 v68, v72, v73, v74
    v_max_u32 v68, v68, v75
    s_nop 1
    v_max_u32_dpp v68, v68, v68 row_ror:8 row_mask:0xf bank_mask:0xf
    s_nop 1
    v_max_u32_dpp v68, v68, v68 row_ror:4 row_mask:0xf bank_mask:0xf
    s_nop 1
    v_max_u32_dpp v68, v68, v68 row_ror:2 row_mask:0xf bank_mask:0xf
    s_nop 1
    v_max_u32_dpp v68, v68, v68 row_ror:1 row_mask:0xf bank_mask:0xf
    s_mov_b32 exec_lo, 0x00010001
    s_mov_b32 exec_hi, 0x00010001
    ds_max_u32 v44, v68
    s_mov_b64 exec, -1
    s_waitcnt lgkmcnt(0)
    s_barrier
    ds_read_b128 v[76:79], v45
    ds_read_b128 v[80:83], v45 offset:16
    s_waitcnt lgkmcnt(0)
    v_min3_u32 v68, v76, v77, v78
    v_min3_u32 v69, v79, v80, v81
    v_min3_u32 v68, v68, v82, v83
    v_min_u32 v68, v68, v69
    v_mov_b32 v69, 0
    v_cmp_ge_u32 vcc, v72, v68
    s_nop 1
    v_addc_co_u32 v69, vcc, 0, v69, vcc
    v_cmp_ge_u32 vcc, v73, v68
    s_nop 1
    v_addc_co_u32 v69, vcc, 0, v69, vcc
    v_cmp_ge_u32 vcc, v74, v68
    s_nop 1
    v_addc_co_u32 v69, vcc, 0, v69, vcc
    v_cmp_ge_u32 vcc, v75, v68
    s_nop 1
    v_addc_co_u32 v69, vcc, 0, v69, vcc
    v_cmp_lt_u32 vcc, 0, v69
    s_nop 0
    s_and_saveexec_b64 s[50:51], vcc
    s_cbranch_execz L_noc31
    ds_add_rtn_u32 v70, v46, v69
    s_waitcnt lgkmcnt(0)
    v_lshlrev_b32 v70, 2, v70
    v_add_u32 v70, 108032, v70
    s_mov_b64 s[48:49], exec
    v_cmp_ge_u32 vcc, v72, v68
    s_nop 0
    s_and_b64 exec, s[48:49], vcc
    ds_write_b32 v70, v72
    v_add_u32 v70, 4, v70
    s_mov_b64 exec, s[48:49]
    v_cmp_ge_u32 vcc, v73, v68
    s_nop 0
    s_and_b64 exec, s[48:49], vcc
    ds_write_b32 v70, v73
    v_add_u32 v70, 4, v70
    s_mov_b64 exec, s[48:49]
    v_cmp_ge_u32 vcc, v74, v68
    s_nop 0
    s_and_b64 exec, s[48:49], vcc
    ds_write_b32 v70, v74
    v_add_u32 v70, 4, v70
    s_mov_b64 exec, s[48:49]
    v_cmp_ge_u32 vcc, v75, v68
    s_nop 0
    s_and_b64 exec, s[48:49], vcc
    ds_write_b32 v70, v75
    v_add_u32 v70, 4, v70
    s_mov_b64 exec, s[48:49]
L_noc31:
    s_mov_b64 exec, s[50:51]
    s_waitcnt lgkmcnt(0)
    s_barrier
    ds_read_b32 v68, v46
    s_mov_b32 s53, 0
L_ro32:
    v_add_u32 v47, s53, v42
    ds_read_b32 v48, v47
    v_mov_b32 v49, 0
    s_mov_b32 s54, 0
L_ri33:
    v_add_u32 v47, s54, v43
    ds_read_b128 v[52:55], v47
    s_waitcnt lgkmcnt(0)
    s_cmp_eq_u32 s54, 0
    s_cbranch_scc0 L_nocp34
    v_and_b32 v56, 0x7ff, v48
    v_sub_u32 v56, 2047, v56
    v_and_b32 v57, 7, v0
    v_lshlrev_b32 v57, 7, v57
    v_lshl_add_u32 v56, v56, 10, v57
    v_cmp_ne_u32 vcc, 0, v48
    s_nop 0
    s_and_saveexec_b64 s[50:51], vcc
    s_cbranch_execz L_nocp34x
    global_load_dword v103, v56, s[64:65] sc1
L_nocp34x:
    s_mov_b64 exec, s[50:51]
L_nocp34:
    v_readfirstlane_b32 s52, v68
    v_cmp_gt_u32 vcc, v52, v48
    s_nop 1
    v_addc_co_u32 v49, vcc, 0, v49, vcc
    v_cmp_gt_u32 vcc, v53, v48
    s_nop 1
    v_addc_co_u32 v49, vcc, 0, v49, vcc
    v_cmp_gt_u32 vcc, v54, v48
    s_nop 1
    v_addc_co_u32 v49, vcc, 0, v49, vcc
    v_cmp_gt_u32 vcc, v55, v48
    s_nop 1
    v_addc_co_u32 v49, vcc, 0, v49, vcc
    s_add_u32 s54, s54, 128
    s_lshl_b32 s48, s52, 2
    s_cmp_lt_u32 s54, s48
    s_nop 1
    s_cbranch_scc1 L_ri33
    v_add_u32_dpp v49, v49, v49 quad_perm:[1,0,3,2] row_mask:0xf bank_mask:0xf
    s_nop 1
    v_add_u32_dpp v49, v49, v49 quad_perm:[2,3,0,1] row_mask:0xf bank_mask:0xf
    s_nop 1
    v_add_u32_dpp v49, v49, v49 row_half_mirror row_mask:0xf bank_mask:0xf
    v_cmp_gt_u32 vcc, 8, v49
    v_cmp_ne_u32 s[48:49], 0, v48
    s_nop 0
    s_and_b64 vcc, vcc, s[48:49]
    s_and_saveexec_b64 s[50:51], vcc
    v_lshlrev_b32 v49, 2, v49
    v_add_u32 v49, 163552, v49
    ds_write_b32 v49, v48
    s_mov_b64 exec, s[50:51]
    s_add_u32 s53, s53, 256
    s_lshl_b32 s48, s52, 2
    s_cmp_lt_u32 s53, s48
    s_cbranch_scc1 L_ro32
    s_waitcnt lgkmcnt(0)
    s_barrier
    s_cmp_ge_u32 s2, 112
    s_cbranch_scc1 L_ffn235
    v_and_b32 v40, 7, v1
    v_lshlrev_b32 v40, 2, v40
    v_add_u32 v40, 163552, v40
    ds_read_b32 v41, v40
    v_lshrrev_b32 v42, 4, v1
    v_lshlrev_b32 v42, 4, v42
    s_lshl_b32 s48, s39, 7
    v_add_u32 v42, s48, v42
    v_mov_b32 v52, 0
    v_mov_b32 v53, 0
    v_mov_b32 v54, 0
    v_mov_b32 v55, 0
    v_mov_b32 v56, 0
    v_mov_b32 v57, 0
    v_mov_b32 v58, 0
    v_mov_b32 v59, 0
    s_waitcnt lgkmcnt(0)
    v_and_b32 v41, 0x7ff, v41
    v_sub_u32 v41, 2047, v41
    v_lshl_add_u32 v41, v41, 10, v42
    global_load_dwordx4 v[44:47], v41, s[64:65] sc1
    global_load_dwordx4 v[48:51], v41, s[64:65] offset:64 sc1
    v_lshrrev_b32 v100, 4, v1
    v_lshlrev_b32 v100, 3, v100
    v_bfe_u32 v101, v1, 2, 2
    v_add_u32 v100, v100, v101
    v_lshlrev_b32 v100, 5, v100
    v_and_b32 v101, 3, v1
    v_lshlrev_b32 v101, 3, v101
    v_add_u32 v100, v100, v101
    s_lshl_b32 s48, s39, 11
    s_add_u32 s48, s48, 0
    v_add_u32 v100, s48, v100
    ds_read_b64_tr_b16 v[104:105], v100 offset:0
    ds_read_b64_tr_b16 v[106:107], v100 offset:128
    ds_read_b64_tr_b16 v[108:109], v100 offset:1024
    ds_read_b64_tr_b16 v[110:111], v100 offset:1152
    ds_read_b64_tr_b16 v[112:113], v100 offset:16384
    ds_read_b64_tr_b16 v[114:115], v100 offset:16512
    ds_read_b64_tr_b16 v[116:117], v100 offset:17408
    ds_read_b64_tr_b16 v[118:119], v100 offset:17536
    s_lshl_b32 s48, s39, 10
    s_add_u32 s48, s48, 116224
    v_add_u32 v40, s48, v16
    v_lshrrev_b32 v60, 4, v0
    v_and_b32 v61, 15, v0
    v_lshrrev_b32 v62, 2, v60
    v_lshlrev_b32 v62, 4, v62
    v_add_u32 v62, v62, v61
    v_lshlrev_b32 v62, 4, v62
    v_and_b32 v63, 3, v60
    v_lshlrev_b32 v63, 2, v63
    v_add_u32 v62, v62, v63
    v_add_u32 v62, 116224, v62
    s_waitcnt vmcnt(1) lgkmcnt(0)
    v_mfma_f32_16x16x32_bf16 v[52:55], v[44:47], v[104:107], v[52:55]
    v_mfma_f32_16x16x32_bf16 v[56:59], v[44:47], v[112:115], v[56:59]
    s_waitcnt vmcnt(0)
    v_mfma_f32_16x16x32_bf16 v[52:55], v[48:51], v[108:111], v[52:55]
    v_mfma_f32_16x16x32_bf16 v[56:59], v[48:51], v[116:119], v[56:59]
    s_mov_b32 exec_hi, 0
    s_nop 5
    ds_write_b128 v40, v[52:55]
    ds_write_b128 v40, v[56:59] offset:512
    s_mov_b64 exec, -1
    s_waitcnt lgkmcnt(0)
    s_barrier
    s_cmp_ge_u32 s39, 2
    s_cbranch_scc1 L_FIN
    ds_read_b32 v44, v62 offset:0
    ds_read_b32 v52, v62 offset:512
    ds_read_b32 v45, v62 offset:1024
    ds_read_b32 v53, v62 offset:1536
    ds_read_b32 v46, v62 offset:2048
    ds_read_b32 v54, v62 offset:2560
    ds_read_b32 v47, v62 offset:3072
    ds_read_b32 v55, v62 offset:3584
    ds_read_b32 v48, v62 offset:4096
    ds_read_b32 v56, v62 offset:4608
    ds_read_b32 v49, v62 offset:5120
    ds_read_b32 v57, v62 offset:5632
    ds_read_b32 v50, v62 offset:6144
    ds_read_b32 v58, v62 offset:6656
    ds_read_b32 v51, v62 offset:7168
    ds_read_b32 v59, v62 offset:7680
    s_lshl_b32 s49, s68, 8
    v_lshlrev_b32 v66, 1, v0
    v_add_u32 v66, s49, v66
    v_mov_b32 v67, 0x05040100
    s_waitcnt lgkmcnt(0)
    v_add_f32 v44, v44, v45
    v_add_f32 v52, v52, v53
    v_add_f32 v46, v46, v47
    v_add_f32 v54, v54, v55
    v_add_f32 v48, v48, v49
    v_add_f32 v56, v56, v57
    v_add_f32 v50, v50, v51
    v_add_f32 v58, v58, v59
    v_add_f32 v44, v44, v46
    v_add_f32 v52, v52, v54
    v_add_f32 v48, v48, v50
    v_add_f32 v56, v56, v58
    v_add_f32 v44, v44, v48
    v_add_f32 v52, v52, v56
    v_cvt_pk_bf16_f32 v44, v44, v52
    v_and_b32 v52, 0xffff0000, v44
    v_lshlrev_b32 v44, 16, v44
    v_mul_f32 v46, 0xbfb8aa3b, v44
    v_exp_f32 v46, v46
    s_nop 0
    v_add_f32 v46, 1.0, v46
    v_rcp_f32 v45, v46
    s_nop 0
    v_mul_f32 v44, v44, v45
    v_cvt_pk_bf16_f32 v44, v44, v44
    v_lshlrev_b32 v44, 16, v44
    v_mul_f32 v44, v44, v52
    v_cvt_pk_bf16_f32 v44, v44, v44
    s_nop 1
    v_mov_b32_dpp v45, v44 quad_perm:[1,1,3,3] row_mask:0xf bank_mask:0xf
    v_perm_b32 v48, v45, v44, v67
    s_nop 1
    v_mov_b32_dpp v49, v48 row_shl:2 row_mask:0xf bank_mask:0xf
    v_mov_b32_dpp v50, v48 row_shl:4 row_mask:0xf bank_mask:0xf
    v_mov_b32_dpp v51, v48 row_shl:6 row_mask:0xf bank_mask:0xf
    v_min_u32 v48, 0xfffffffe, v48
    v_min_u32 v49, 0xfffffffe, v49
    v_min_u32 v50, 0xfffffffe, v50
    v_min_u32 v51, 0xfffffffe, v51
    s_mov_b32 exec_lo, 0x01010101
    s_mov_b32 exec_hi, 0x01010101
    global_store_dwordx4 v66, v[48:51], s[62:63] sc1
    s_mov_b64 exec, -1
    s_branch L_FIN
L_ffn235:
    v_bfe_u32 v40, v0, 3, 3
    v_lshlrev_b32 v40, 2, v40
    v_add_u32 v40, 163552, v40
    ds_read_b32 v60, v40
    s_waitcnt lgkmcnt(0)
    v_and_b32 v41, 0x7ff, v60
    v_sub_u32 v41, 2047, v41
    v_lshlrev_b32 v41, 10, v41
    v_and_b32 v42, 7, v0
    v_lshlrev_b32 v42, 1, v42
    s_lshl_b32 s48, s68, 4
    v_add3_u32 v61, v41, v42, s48
    v_mov_b32 v62, 0
    v_mov_b32 v63, 0
    global_load_short_d16_hi v62, v61, s[66:67] sc1
    global_load_short_d16_hi v63, v61, s[64:65] sc1
    v_and_b32 v64, 0xffff0000, v60
    v_ashrrev_i32 v65, 31, v64
    v_not_b32 v65, v65
    v_or_b32 v65, 0x80000000, v65
    v_xor_b32 v64, v64, v65
    v_and_b32 v64, 0xffff0000, v64
    v_mul_f32 v66, 0xbfb8aa3b, v64
    v_exp_f32 v66, v66
    s_nop 0
    v_add_f32 v66, 1.0, v66
    v_rcp_f32 v65, v66
    s_nop 0
    v_cvt_pk_bf16_f32 v65, v65, v65
    v_lshlrev_b32 v65, 16, v65
    v_and_b32 v40, 7, v1
    v_lshlrev_b32 v40, 5, v40
    v_bfe_u32 v41, v1, 4, 1
    v_lshlrev_b32 v41, 4, v41
    v_lshrrev_b32 v42, 5, v1
    v_lshlrev_b32 v42, 8, v42
    v_add3_u32 v40, v40, v41, v42
    s_mul_i32 s48, s39, 3584
    v_add_u32 v40, s48, v40
    s_lshl_b32 s48, s39, 10
    s_add_u32 s48, s48, 116224
    v_add_u32 v67, s48, v16
    v_bfe_u32 v44, v0, 3, 3
    v_and_b32 v45, 7, v0
    v_lshrrev_b32 v46, 2, v44
    v_lshlrev_b32 v46, 4, v46
    v_add_u32 v46, v46, v45
    v_lshlrev_b32 v46, 4, v46
    v_and_b32 v47, 3, v44
    v_lshlrev_b32 v47, 2, v47
    v_add_u32 v46, v46, v47
    v_add_u32 v59, 116224, v46
    v_mov_b32 v52, 0
    v_mov_b32 v53, 0
    v_mov_b32 v54, 0
    v_mov_b32 v55, 0
    v_lshrrev_b32 v100, 4, v1
    v_lshlrev_b32 v100, 3, v100
    v_bfe_u32 v101, v1, 2, 2
    v_add_u32 v100, v100, v101
    v_lshlrev_b32 v100, 4, v100
    v_and_b32 v101, 1, v1
    v_lshlrev_b32 v101, 3, v101
    v_add_u32 v100, v100, v101
    s_mul_i32 s48, s39, 3584
    s_add_u32 s48, s48, 0
    v_add_u32 v100, s48, v100
    ds_read_b64_tr_b16 v[104:105], v100 offset:0
    ds_read_b64_tr_b16 v[106:107], v100 offset:64
    ds_read_b64_tr_b16 v[108:109], v100 offset:512
    ds_read_b64_tr_b16 v[110:111], v100 offset:576
    ds_read_b64_tr_b16 v[112:113], v100 offset:1024
    ds_read_b64_tr_b16 v[114:115], v100 offset:1088
    ds_read_b64_tr_b16 v[116:117], v100 offset:1536
    ds_read_b64_tr_b16 v[118:119], v100 offset:1600
    ds_read_b64_tr_b16 v[120:121], v100 offset:2048
    ds_read_b64_tr_b16 v[122:123], v100 offset:2112
    ds_read_b64_tr_b16 v[124:125], v100 offset:2560
    ds_read_b64_tr_b16 v[126:127], v100 offset:2624
    ds_read_b64_tr_b16 v[128:129], v100 offset:3072
    ds_read_b64_tr_b16 v[130:131], v100 offset:3136
    s_waitcnt lgkmcnt(0)
    s_sleep 40
    s_mov_b32 s55, 0
    global_load_dwordx4 v[68:71], v40, s[62:63] offset:0 sc1
    global_load_dwordx4 v[72:75], v40, s[62:63] offset:512 sc1
    global_load_dwordx4 v[76:79], v40, s[62:63] offset:1024 sc1
    global_load_dwordx4 v[80:83], v40, s[62:63] offset:1536 sc1
    global_load_dwordx4 v[84:87], v40, s[62:63] offset:2048 sc1
    global_load_dwordx4 v[88:91], v40, s[62:63] offset:2560 sc1
    global_load_dwordx4 v[92:95], v40, s[62:63] offset:3072 sc1
L_ap36:
    s_waitcnt vmcnt(0)
    v_max3_u32 v58, v68, v69, v70
    v_max3_u32 v58, v58, v71, v72
    v_max3_u32 v58, v58, v73, v74
    v_max3_u32 v58, v58, v75, v76
    v_max3_u32 v58, v58, v77, v78
    v_max3_u32 v58, v58, v79, v80
    v_max3_u32 v58, v58, v81, v82
    v_max3_u32 v58, v58, v83, v84
    v_max3_u32 v58, v58, v85, v86
    v_max3_u32 v58, v58, v87, v88
    v_max3_u32 v58, v58, v89, v90
    v_max3_u32 v58, v58, v91, v92
    v_max3_u32 v58, v58, v93, v94
    v_max_u32 v58, v58, v95
    v_cmp_eq_u32 vcc, -1, v58
    s_cbranch_vccz L_aok37
    s_add_u32 s55, s55, 1
    s_cmp_lt_u32 s55, 0x20000
    s_cbranch_scc0 L_aok37
    s_and_b64 exec, exec, vcc
    s_sleep 4
    global_load_dwordx4 v[68:71], v40, s[62:63] offset:0 sc1
    global_load_dwordx4 v[72:75], v40, s[62:63] offset:512 sc1
    global_load_dwordx4 v[76:79], v40, s[62:63] offset:1024 sc1
    global_load_dwordx4 v[80:83], v40, s[62:63] offset:1536 sc1
    global_load_dwordx4 v[84:87], v40, s[62:63] offset:2048 sc1
    global_load_dwordx4 v[88:91], v40, s[62:63] offset:2560 sc1
    global_load_dwordx4 v[92:95], v40, s[62:63] offset:3072 sc1
    s_branch L_ap36
L_aok37:
    s_mov_b64 exec, -1
    v_mfma_f32_16x16x32_bf16 v[52:55], v[68:71], v[104:107], v[52:55]
    v_mfma_f32_16x16x32_bf16 v[52:55], v[72:75], v[108:111], v[52:55]
    v_mfma_f32_16x16x32_bf16 v[52:55], v[76:79], v[112:115], v[52:55]
    v_mfma_f32_16x16x32_bf16 v[52:55], v[80:83], v[116:119], v[52:55]
    v_mfma_f32_16x16x32_bf16 v[52:55], v[84:87], v[120:123], v[52:55]
    v_mfma_f32_16x16x32_bf16 v[52:55], v[88:91], v[124:127], v[52:55]
    v_mfma_f32_16x16x32_bf16 v[52:55], v[92:95], v[128:131], v[52:55]
    s_mov_b32 exec_hi, 0
    s_nop 6
    ds_write_b128 v67, v[52:55]
    s_mov_b64 exec, -1
    s_waitcnt lgkmcnt(0)
    s_barrier
    s_cmp_ge_u32 s39, 1
    s_cbranch_scc1 L_FIN
    ds_read_b32 v44, v59 offset:0
    ds_read_b32 v45, v59 offset:1024
    ds_read_b32 v46, v59 offset:2048
    ds_read_b32 v47, v59 offset:3072
    ds_read_b32 v48, v59 offset:4096
    ds_read_b32 v49, v59 offset:5120
    ds_read_b32 v50, v59 offset:6144
    ds_read_b32 v51, v59 offset:7168
    s_waitcnt lgkmcnt(0)
    v_add_f32 v44, v44, v45
    v_add_f32 v46, v46, v47
    v_add_f32 v48, v48, v49
    v_add_f32 v50, v50, v51
    v_add_f32 v44, v44, v46
    v_add_f32 v48, v48, v50
    v_add_f32 v44, v44, v48
    v_cvt_pk_bf16_f32 v44, v44, v44
    v_lshlrev_b32 v44, 16, v44
    v_mul_f32 v44, v44, v65
    v_cvt_pk_bf16_f32 v44, v44, v44
    v_lshlrev_b32 v44, 16, v44
    v_add_f32 v44, v63, v44
    v_cvt_pk_bf16_f32 v44, v44, v44
    v_lshlrev_b32 v44, 16, v44
    v_add_f32 v44, v62, v44
    v_cvt_pk_bf16_f32 v44, v44, v44
    global_store_short v61, v44, s[32:33]
    s_branch L_FIN
L_SERVICE:
    s_mul_i32 s48, s38, 8320
    v_add_u32 v22, s48, v16
    v_add_u32 v19, 4096, v22
    v_mov_b32 v24, -1
    v_mov_b32 v25, -1
    v_mov_b32 v26, -1
    v_mov_b32 v27, -1
    v_mov_b32 v28, 0
    v_mov_b32 v29, 0
    v_mov_b32 v30, 0
    v_mov_b32 v31, 0
    v_lshlrev_b32 v18, 7, v1
    v_add_u32 v18, s48, v18
    s_waitcnt lgkmcnt(0)
    s_load_dword s44, s[36:37], 0
    s_add_u32 s56, s36, 0x10000
    s_addc_u32 s57, s37, 0
    s_add_u32 s58, s36, 0x218000
    s_addc_u32 s59, s37, 0
    s_add_u32 s60, s36, 0x420000
    s_addc_u32 s61, s37, 0
    s_add_u32 s62, s36, 0x422000
    s_addc_u32 s63, s37, 0
    s_add_u32 s64, s36, 0x430000
    s_addc_u32 s65, s37, 0
    s_add_u32 s66, s36, 0x630000
    s_addc_u32 s67, s37, 0
    s_and_b32 s48, s2, 7
    s_mul_i32 s49, s48, 14
    s_lshr_b32 s50, s2, 3
    s_add_u32 s49, s49, s50
    s_lshl_b32 s48, s48, 3
    s_sub_u32 s50, s50, 14
    s_add_u32 s48, s48, s50
    s_cmp_lt_u32 s2, 112
    s_cselect_b32 s68, s49, s48
    global_load_dwordx4 v[8:11], v16, s[20:21]
    global_load_dwordx4 v[12:15], v16, s[24:25]
    s_cmp_ge_u32 s2, 176
    s_cbranch_scc1 L_pfd39
    s_cmp_ge_u32 s2, 112
    s_cbranch_scc1 L_pf238
    v_lshrrev_b32 v40, 2, v1
    v_and_b32 v41, 3, v1
    s_lshr_b32 s48, s2, 3
    v_mul_u32_u24 v40, 14, v40
    v_add_u32 v40, s48, v40
    s_and_b32 s48, s2, 7
    s_mul_i32 s48, s48, 448
    s_and_b32 s48, s48, 0xffffff80
    s_movk_i32 s49, 3584
    v_mul_lo_u32 v42, v40, s49
    v_lshlrev_b32 v41, 7, v41
    v_add3_u32 v42, v42, v41, s48
    s_mov_b32 s50, 0
L_pf140:
    v_cmp_gt_u32 vcc, 512, v40
    s_nop 0
    s_and_saveexec_b64 s[48:49], vcc
    v_min_u32 v45, 1835004, v42
    global_load_dword v43, v45, s[26:27]
    global_load_dword v44, v45, s[28:29]
    s_mov_b64 exec, s[48:49]
    v_add_u32 v40, 224, v40
    v_add_u32 v42, 802816, v42
    s_add_u32 s50, s50, 1
    s_cmp_lt_u32 s50, 3
    s_cbranch_scc1 L_pf140
    s_branch L_pfd39
L_pf238:
    s_sub_u32 s48, s2, 112
    s_lshr_b32 s49, s48, 3
    s_and_b32 s48, s48, 7
    s_lshl_b32 s48, s48, 7
    s_mul_i32 s49, s49, 224
    v_add_u32 v40, s49, v1
    v_lshlrev_b32 v40, 10, v40
    v_add_u32 v40, s48, v40
    global_load_dword v43, v40, s[30:31]
    v_add_u32 v40, 65536, v40
    global_load_dword v43, v40, s[30:31]
    v_add_u32 v40, 65536, v40
    global_load_dword v43, v40, s[30:31]
    v_add_u32 v40, 65536, v40
    s_mov_b32 exec_hi, 0
    global_load_dword v43, v40, s[30:31]
    s_mov_b64 exec, -1
L_pfd39:
    v_add_u32 v32, 68544, v16
    ds_write_b128 v32, v[28:31] offset:0
    ds_write_b128 v32, v[28:31] offset:1024
    ds_write_b128 v32, v[28:31] offset:2048
    s_mov_b64 exec, 15
    ds_write_b128 v32, v[28:31] offset:3072
    s_mov_b64 exec, -1
    v_add_u32 v32, 84224, v16
    ds_write_b128 v32, v[28:31] offset:0
    ds_write_b128 v32, v[28:31] offset:1024
    s_mov_b32 exec_hi, 0
    ds_write_b128 v32, v[28:31] offset:2048
    s_mov_b64 exec, -1
    v_add_u32 v32, 81088, v16
    ds_write_b128 v32, v[28:31] offset:0
    ds_write_b128 v32, v[28:31] offset:1024
    ds_write_b128 v32, v[28:31] offset:2048
    s_mov_b64 exec, 15
    ds_write_b128 v32, v[28:31] offset:3072
    s_mov_b64 exec, -1
    v_add_u32 v32, 91904, v16
    ds_write_b128 v32, v[28:31] offset:0
    ds_write_b128 v32, v[28:31] offset:1024
    s_mov_b32 exec_hi, 0
    ds_write_b128 v32, v[28:31] offset:2048
    s_mov_b64 exec, -1
    v_lshrrev_b32 v32, 2, v1
    v_mul_u32_u24 v32, 2112, v32
    v_and_b32 v33, 3, v1
    v_lshlrev_b32 v33, 4, v33
    v_add_u32 v32, v32, v33
    v_add_u32 v32, 99584, v32
    s_mov_b64 exec, 0xffff
    ds_write_b128 v32, v[28:31]
    s_mov_b64 exec, -1
    v_mov_b32 v32, 163328
    s_mov_b64 exec, 1
    ds_write_b128 v32, v[28:31]
    s_mov_b64 exec, -1
    s_waitcnt lgkmcnt(0)
    s_add_u32 s44, s44, 1
    s_bfe_u32 s48, s44, 0x30000
    s_bfe_u32 s49, s44, 0x30003
    s_lshl_b32 s49, s49, 16
    s_or_b32 s40, s48, s49
    s_bfe_u32 s48, s44, 0x30006
    s_bfe_u32 s49, s44, 0x30009
    s_lshl_b32 s49, s49, 16
    s_or_b32 s41, s48, s49
    s_bfe_u32 s48, s44, 0x3000c
    s_bfe_u32 s49, s44, 0x3000f
    s_lshl_b32 s49, s49, 16
    s_or_b32 s42, s48, s49
    s_bfe_u32 s48, s44, 0x30012
    s_bfe_u32 s49, s44, 0x30015
    s_lshl_b32 s49, s49, 16
    s_or_b32 s43, s48, s49
    s_xor_b32 s48, s40, 0x00010001
    v_mov_b32 v32, s48
    s_xor_b32 s48, s41, 0x00010001
    v_mov_b32 v33, s48
    s_xor_b32 s48, s42, 0x00010001
    v_mov_b32 v34, s48
    s_xor_b32 s48, s43, 0x00010001
    v_mov_b32 v35, s48
    global_store_dwordx4 v22, v[32:35], s[58:59] offset:0 sc1
    global_store_dwordx4 v22, v[32:35], s[58:59] offset:1024 sc1
    global_store_dwordx4 v22, v[32:35], s[58:59] offset:2048 sc1
    global_store_dwordx4 v22, v[32:35], s[58:59] offset:3072 sc1
    global_store_dwordx4 v19, v[32:35], s[58:59] offset:0 sc1
    global_store_dwordx4 v19, v[32:35], s[58:59] offset:1024 sc1
    global_store_dwordx4 v19, v[32:35], s[58:59] offset:2048 sc1
    global_store_dwordx4 v19, v[32:35], s[58:59] offset:3072 sc1
    s_lshl_b32 s48, s38, 5
    v_add_u32 v23, s48, v16
    s_mov_b64 exec, 3
    global_store_dwordx4 v23, v[28:31], s[60:61] sc1
    s_mov_b64 exec, -1
    s_cmp_lt_u32 s2, 112
    s_cbranch_scc0 L_na41
    s_lshl_b32 s48, s68, 8
    v_add_u32 v23, s48, v16
    s_mov_b64 exec, 0xffff
    global_store_dwordx4 v23, v[24:27], s[62:63] sc1
    s_mov_b64 exec, -1
L_na41:
    s_barrier
    s_cmp_ge_u32 s2, 176
    s_cbranch_scc0 L_w843
    s_waitcnt vmcnt(9)
    s_branch L_wj44
L_w843:
    s_cmp_ge_u32 s2, 112
    s_cbranch_scc1 L_w742
    s_waitcnt vmcnt(16)
    s_branch L_wj44
L_w742:
    s_waitcnt vmcnt(13)
L_wj44:
    v_add_u32 v23, 117248, v16
    ds_write_b128 v23, v[8:11]
    ds_write_b128 v23, v[12:15] offset:1024
    v_lshrrev_b32 v46, 1, v1
    v_and_b32 v47, 1, v1
    v_lshlrev_b32 v47, 4, v47
    s_cmp_ge_u32 s2, 112
    s_cbranch_scc1 L_da245
    s_movk_i32 s49, 3584
    v_mul_lo_u32 v46, v46, s49
    s_lshl_b32 s48, s68, 5
    v_add3_u32 v46, v46, v47, s48
    s_branch L_daj46
L_da245:
    v_lshlrev_b32 v46, 10, v1
    s_lshl_b32 s48, s68, 4
    v_add_u32 v46, s48, v46
L_daj46:
    s_waitcnt lgkmcnt(0)
    s_barrier
    s_barrier
    s_barrier
    s_cmp_ge_u32 s2, 176
    s_cbranch_scc0 L_w848
    s_waitcnt vmcnt(0)
    s_barrier
    s_branch L_SEND
L_w848:
    s_cmp_ge_u32 s2, 112
    s_cbranch_scc1 L_w747
    s_waitcnt vmcnt(0)
    s_branch L_wj49
L_w747:
    s_waitcnt vmcnt(0)
L_wj49:
    s_mov_b32 s52, 0
    s_mov_b32 s50, 0
    s_add_u32 s50, s50, 4
    s_cmp_ge_u32 s2, 112
    s_cbranch_scc1 L_dma250
    s_lshl_b32 s51, s50, 12
    s_add_u32 s51, s51, 0
L_d152:
    s_mov_b32 m0, s52
    s_nop 0
    global_load_lds_dwordx4 v46, s[26:27]
    s_add_u32 m0, s52, 16384
    s_nop 0
    global_load_lds_dwordx4 v46, s[28:29]
    v_add_u32 v46, 114688, v46
    s_add_u32 s52, s52, 1024
    s_cmp_lt_u32 s52, s51
    s_cbranch_scc1 L_d152
    s_branch L_dmad51
L_dma250:
    s_mul_i32 s51, s50, 7168
    s_add_u32 s51, s51, 0
L_d253:
    s_mov_b32 m0, s52
    s_nop 0
    global_load_lds_dwordx4 v46, s[30:31]
    v_add_u32 v46, 65536, v46
    s_add_u32 s52, s52, 1024
    s_cmp_lt_u32 s52, s51
    s_cbranch_scc1 L_d253
L_dmad51:
    s_barrier
    s_barrier
    s_barrier
    s_barrier
    s_barrier
    s_barrier
    s_waitcnt vmcnt(0)
    s_barrier
L_SEND:
    s_branch L_END
L_FIN:
L_END:
    s_endpgm
L_CODE_END:
.section .rodata,"a"
.p2align 6
.amdhsa_kernel sequential_preLN__ssm_conv_s4d__moe_arch_mod__prompt_kernel
  .amdhsa_next_free_vgpr 168
  .amdhsa_next_free_sgpr 102
  .amdhsa_accum_offset 168
  .amdhsa_group_segment_fixed_size 0
  .amdhsa_kernarg_size 120
  .amdhsa_user_sgpr_count 2
  .amdhsa_user_sgpr_kernarg_segment_ptr 1
  .amdhsa_system_sgpr_workgroup_id_x 1
.end_amdhsa_kernel
```
